```python
import torch

def _softmax(x, axis=-1):
    return torch.softmax(x, dim=axis)
def _gelu(x):
    return torch.nn.functional.gelu(x, approximate="tanh")
def _silu(x):
    return torch.nn.functional.silu(x)
def _sigmoid(x):
    return torch.sigmoid(x)
def _layernorm(x, axis=-1, eps=1e-5):
    m = x.mean(dim=axis, keepdim=True)
    v = x.var(dim=axis, keepdim=True, unbiased=False)
    return (x - m) / torch.sqrt(v + eps)
def _scatter_add(tgt, idx, src, axis=0):
    return tgt.clone().index_add_(axis, idx, src)
def _segment_sum(src, seg, n):
    out = torch.zeros((n,) + src.shape[1:], dtype=src.dtype)
    return out.index_add_(0, seg, src)
def _pad(x, pw):
    flat = tuple(v for pair in reversed(pw) for v in pair)
    return torch.nn.functional.pad(x, flat)

kernel_name = 'standalone__mha_softmax__near_ridge'

def setup_inputs():

    _w = (lambda a: (lambda t: t.to(torch.bfloat16) if t.is_floating_point() else t)(torch.as_tensor(a)))
    B, H, Sq, Sk, D = 8, 32, 256, 1024, 128
    return {
        "q": _w((lambda *s: torch.randn(*s, dtype=torch.bfloat16) * 0.8)(B, H, Sq, D)),
        "k": _w((lambda *s: torch.randn(*s, dtype=torch.bfloat16) * 0.8)(B, H, Sk, D)),
        "v": _w((lambda *s: torch.randn(*s, dtype=torch.bfloat16) * 0.05)(B, H, Sk, D)),
    }

def reference(q, k, v):
    scale = q.shape[-1] ** -0.5
    scores = torch.einsum("bhqd,bhkd->bhqk", q, k) * scale
    p = _softmax(scores, axis=-1)
    return torch.einsum("bhqk,bhkd->bhqd", p, v)
```

```asm
; @launch grid=(256,1,1) block=(256,1,1) lds=163840
.amdgcn_target "amdgcn-amd-amdhsa--gfx950"
.text
.globl standalone__mha_softmax__near_ridge_kernel
.p2align 8
.type standalone__mha_softmax__near_ridge_kernel,@function
standalone__mha_softmax__near_ridge_kernel:
    s_cmp_ge_u32 s2, 256
    s_cbranch_scc1 L_end
    s_load_dwordx4 s[32:35], s[0:1], 0
    s_load_dwordx4 s[36:39], s[0:1], 16
    s_getpc_b64 s[44:45]
L_pc:
    s_add_u32 s44, s44, L_exit - L_pc
    s_addc_u32 s45, s45, 0
    s_mov_b32 s48, (L_end - L_exit + 127) / 128
    s_cmp_ge_u32 s2, 64
    v_lshlrev_b32 v2, 7, v0
    v_mov_b32 v3, s45
    v_add_co_u32 v2, vcc, s44, v2
    v_cmp_gt_u32 s[46:47], s48, v0
    v_addc_co_u32 v3, vcc, 0, v3, vcc
    s_cbranch_scc1 L_nocpf
    s_and_saveexec_b64 s[44:45], s[46:47]
    s_cbranch_execz L_cpfdone
    global_load_dword v40, v[2:3], off
L_cpfdone:
    s_mov_b64 exec, s[44:45]
L_nocpf:
    v_lshrrev_b32 v1, 6, v0
    v_and_b32 v0, 63, v0
    v_lshrrev_b32 v2, 4, v0
    v_readfirstlane_b32 s20, v1
    v_and_b32 v3, 15, v0
    v_lshlrev_b32 v49, 11, v1
    v_lshl_add_u32 v49, v2, 8, v49
    v_lshlrev_b32 v48, 1, v2
    v_xor_b32 v48, v48, v3
    v_lshl_add_u32 v16, v48, 4, v49
    v_xor_b32 v17, 0x80, v16
    v_xor_b32 v48, v2, v3
    v_lshl_add_u32 v20, v48, 4, v49
    v_xor_b32 v21, 0x80, v20
    s_lshl_b32 s21, s20, 11
    s_lshl_b32 s52, s20, 14
    s_mul_i32 s30, s20, 14336
    s_add_u32 s28, s52, 32768
    s_lshl_b32 s42, s2, 16
    s_lshl_b32 s43, s2, 18
    s_mov_b32 s22, 0
    s_mov_b32 s23, 0
    s_waitcnt lgkmcnt(0)
    s_add_u32 s8, s34, s43
    s_addc_u32 s9, s35, 0
    s_mov_b32 s10, 253952
    s_mov_b32 s11, 0x20000
    s_add_u32 m0, s21, 98304
    s_nop 0
    buffer_load_dwordx4 v16, s[8:11], s22 offen nt lds
    buffer_load_dwordx4 v17, s[8:11], s22 offen offset:1024 nt lds
    s_add_u32 s22, s22, 8192
    s_add_u32 m0, s21, 106496
    s_nop 0
    buffer_load_dwordx4 v16, s[8:11], s22 offen nt lds
    buffer_load_dwordx4 v17, s[8:11], s22 offen offset:1024 nt lds
    s_add_u32 s22, s22, 8192
    s_add_u32 s4, s32, s42
    s_addc_u32 s5, s33, 0
    s_mov_b32 s6, 65536
    s_mov_b32 s7, 0x20000
    s_add_u32 m0, s28, 0
    s_add_u32 s31, s30, 0
    buffer_load_dwordx4 v16, s[4:7], s31 offen nt lds
    buffer_load_dwordx4 v17, s[4:7], s31 offen offset:1024 nt lds
    buffer_load_dwordx4 v16, s[4:7], s31 offen offset:2048 nt lds
    buffer_load_dwordx4 v17, s[4:7], s31 offen offset:3072 nt lds
    s_add_u32 s12, s36, s43
    s_addc_u32 s13, s37, 0
    s_mov_b32 s14, 237568
    s_mov_b32 s15, 0x20000
    s_add_u32 m0, s21, 0
    s_nop 0
    buffer_load_dwordx4 v20, s[12:15], s23 offen nt lds
    buffer_load_dwordx4 v21, s[12:15], s23 offen offset:1024 nt lds
    s_add_u32 s23, s23, 8192
    s_add_u32 m0, s21, 114688
    s_nop 0
    buffer_load_dwordx4 v16, s[8:11], s22 offen nt lds
    buffer_load_dwordx4 v17, s[8:11], s22 offen offset:1024 nt lds
    s_add_u32 s22, s22, 8192
    s_add_u32 s16, s38, s42
    s_addc_u32 s17, s39, 0
    s_mov_b32 s18, 65536
    s_mov_b32 s19, 0x20000
    s_add_u32 s64, s36, s43
    s_addc_u32 s65, s37, 0
    s_mov_b32 s66, 262144
    s_mov_b32 s67, 0x20000
    s_add_u32 s69, s21, 40960
    s_add_u32 s71, s21, 90112
    s_add_u32 s59, s21, 131072
    s_mov_b32 s60, 0
    s_mov_b32 s68, 237568
    v_and_b32 v48, 7, v3
    v_lshlrev_b32 v48, 1, v48
    v_xor_b32 v48, v48, v2
    v_lshlrev_b32 v48, 4, v48
    v_lshl_add_u32 v52, v3, 8, v48
    v_lshrrev_b32 v48, 2, v3
    v_lshl_add_u32 v49, v2, 2, v48
    v_lshlrev_b32 v49, 8, v49
    v_and_b32 v50, 2, v3
    v_lshl_or_b32 v48, v50, 1, v48
    v_and_b32 v50, 1, v2
    v_lshl_or_b32 v48, v50, 3, v48
    v_lshl_add_u32 v49, v48, 4, v49
    v_and_b32 v50, 1, v3
    v_lshl_add_u32 v53, v50, 3, v49
    v_add_u32 v4, 65536, v52
    v_add_u32 v212, s28, v52
    v_mov_b32 v8, v53
    v_xor_b32 v5, 64, v4
    v_xor_b32 v213, 64, v212
    v_xor_b32 v6, 128, v4
    v_xor_b32 v214, 128, v212
    v_xor_b32 v7, 192, v4
    v_xor_b32 v215, 192, v212
    v_xor_b32 v9, 16, v8
    v_xor_b32 v10, 32, v8
    v_xor_b32 v11, 48, v8
    v_xor_b32 v12, 128, v8
    v_xor_b32 v13, 144, v8
    v_xor_b32 v14, 160, v8
    v_xor_b32 v15, 176, v8
    v_mov_b32 v48, 0x3f803f80
    s_mov_b32 s26, 0x3e0293ee
    s_mov_b32 s29, 0x53800000
    s_lshl_b32 s56, s20, 13
    s_add_u32 s56, s56, 131072
    v_accvgpr_write_b32 a240, v48
    v_accvgpr_write_b32 a241, v48
    v_accvgpr_write_b32 a242, v48
    v_accvgpr_write_b32 a243, v48
    v_and_b32 v48, 1, v2
    v_lshlrev_b32 v48, 2, v48
    v_xor_b32 v48, v48, v3
    v_lshlrev_b32 v48, 3, v48
    v_lshl_add_u32 v48, v2, 10, v48
    v_add_u32 v19, s56, v48
    v_mov_b32 v3, v20
    v_mov_b32 v18, v21
    s_add_u32 s53, s52, 4096
    s_add_u32 s54, s52, 8192
    s_add_u32 s55, s52, 12288
    s_waitcnt vmcnt(4)
    s_barrier
    s_add_u32 m0, s28, 4096
    s_add_u32 s31, s30, 4096
    buffer_load_dwordx4 v16, s[4:7], s31 offen nt lds
    buffer_load_dwordx4 v17, s[4:7], s31 offen offset:1024 nt lds
    buffer_load_dwordx4 v16, s[4:7], s31 offen offset:2048 nt lds
    buffer_load_dwordx4 v17, s[4:7], s31 offen offset:3072 nt lds
    s_add_u32 m0, s21, 8192
    ds_read_b128 v[148:151], v212 offset:0
    buffer_load_dwordx4 v20, s[12:15], s23 offen nt lds
    buffer_load_dwordx4 v21, s[12:15], s23 offen offset:1024 nt lds
    s_add_u32 s23, s23, 8192
    ds_read_b128 v[164:167], v213 offset:0
    ds_read_b128 v[180:183], v214 offset:0
    ds_read_b128 v[196:199], v215 offset:0
    ds_read_b128 v[120:123], v4 offset:32768
    ds_read_b128 v[252:255], v4 offset:36864
    ds_read_b128 v[124:127], v5 offset:32768
    ds_read_b128 v[36:39], v5 offset:36864
    ds_read_b128 v[228:231], v6 offset:32768
    ds_read_b128 a[236:239], v6 offset:36864
    ds_read_b128 v[240:243], v7 offset:32768
    ds_read_b128 a[60:63], v7 offset:36864
    ds_read_b128 a[96:99], v4 offset:40960
    s_waitcnt lgkmcnt(12)
    ds_read_b128 a[112:115], v4 offset:45056
    s_waitcnt lgkmcnt(12)
    ds_read_b128 a[100:103], v5 offset:40960
    s_waitcnt lgkmcnt(12)
    ds_read_b128 a[116:119], v5 offset:45056
    s_waitcnt lgkmcnt(12)
    ds_read_b128 a[104:107], v6 offset:40960
    s_waitcnt lgkmcnt(12)
    ds_read_b128 a[120:123], v6 offset:45056
    s_waitcnt lgkmcnt(12)
    ds_read_b128 a[108:111], v7 offset:40960
    s_waitcnt lgkmcnt(12)
    ds_read_b128 a[124:127], v7 offset:45056
    v_lshlrev_b32 v1, 16, v148
    v_and_b32 v2, 0xffff0000, v148
    v_mul_f32 v1, s26, v1
    v_mul_f32 v2, s26, v2
    v_cvt_pk_bf16_f32 v148, v1, v2
    v_lshlrev_b32 v22, 16, v149
    v_and_b32 v23, 0xffff0000, v149
    v_mul_f32 v22, s26, v22
    v_mul_f32 v23, s26, v23
    v_cvt_pk_bf16_f32 v149, v22, v23
    v_lshlrev_b32 v1, 16, v150
    v_and_b32 v2, 0xffff0000, v150
    v_mul_f32 v1, s26, v1
    v_mul_f32 v2, s26, v2
    v_cvt_pk_bf16_f32 v150, v1, v2
    v_lshlrev_b32 v22, 16, v151
    v_and_b32 v23, 0xffff0000, v151
    v_mul_f32 v22, s26, v22
    v_mul_f32 v23, s26, v23
    v_cvt_pk_bf16_f32 v151, v22, v23
    v_lshlrev_b32 v1, 16, v164
    v_and_b32 v2, 0xffff0000, v164
    v_mfma_f32_16x16x32_bf16 v[40:43], v[120:123], v[148:151], 0
    s_waitcnt lgkmcnt(2)
    v_mul_f32 v1, s26, v1
    v_mul_f32 v2, s26, v2
    v_mfma_f32_16x16x32_bf16 v[44:47], v[252:255], v[148:151], 0
    s_waitcnt lgkmcnt(1)
    v_cvt_pk_bf16_f32 v164, v1, v2
    v_lshlrev_b32 v22, 16, v165
    v_mfma_f32_16x16x32_bf16 v[56:59], a[96:99], v[148:151], 0
    s_waitcnt lgkmcnt(0)
    v_and_b32 v23, 0xffff0000, v165
    v_mul_f32 v22, s26, v22
    v_mfma_f32_16x16x32_bf16 v[60:63], a[112:115], v[148:151], 0
    v_mul_f32 v23, s26, v23
    v_cvt_pk_bf16_f32 v165, v22, v23
    v_lshlrev_b32 v1, 16, v166
    v_and_b32 v2, 0xffff0000, v166
    v_mul_f32 v1, s26, v1
    v_mul_f32 v2, s26, v2
    v_cvt_pk_bf16_f32 v166, v1, v2
    v_lshlrev_b32 v22, 16, v167
    v_and_b32 v23, 0xffff0000, v167
    v_mul_f32 v22, s26, v22
    v_mul_f32 v23, s26, v23
    v_cvt_pk_bf16_f32 v167, v22, v23
    v_lshlrev_b32 v1, 16, v180
    v_and_b32 v2, 0xffff0000, v180
    v_mfma_f32_16x16x32_bf16 v[40:43], v[124:127], v[164:167], v[40:43]
    v_mul_f32 v1, s26, v1
    v_mul_f32 v2, s26, v2
    v_mfma_f32_16x16x32_bf16 v[44:47], v[36:39], v[164:167], v[44:47]
    v_cvt_pk_bf16_f32 v180, v1, v2
    v_lshlrev_b32 v22, 16, v181
    v_mfma_f32_16x16x32_bf16 v[56:59], a[100:103], v[164:167], v[56:59]
    v_and_b32 v23, 0xffff0000, v181
    v_mul_f32 v22, s26, v22
    v_mfma_f32_16x16x32_bf16 v[60:63], a[116:119], v[164:167], v[60:63]
    v_mul_f32 v23, s26, v23
    v_cvt_pk_bf16_f32 v181, v22, v23
    v_lshlrev_b32 v1, 16, v182
    v_and_b32 v2, 0xffff0000, v182
    v_mul_f32 v1, s26, v1
    v_mul_f32 v2, s26, v2
    v_cvt_pk_bf16_f32 v182, v1, v2
    v_lshlrev_b32 v22, 16, v183
    v_and_b32 v23, 0xffff0000, v183
    v_mul_f32 v22, s26, v22
    v_mul_f32 v23, s26, v23
    v_cvt_pk_bf16_f32 v183, v22, v23
    v_lshlrev_b32 v1, 16, v196
    v_and_b32 v2, 0xffff0000, v196
    v_mfma_f32_16x16x32_bf16 v[40:43], v[228:231], v[180:183], v[40:43]
    v_mul_f32 v1, s26, v1
    v_mul_f32 v2, s26, v2
    v_mfma_f32_16x16x32_bf16 v[44:47], a[236:239], v[180:183], v[44:47]
    v_cvt_pk_bf16_f32 v196, v1, v2
    v_lshlrev_b32 v22, 16, v197
    v_mfma_f32_16x16x32_bf16 v[56:59], a[104:107], v[180:183], v[56:59]
    v_and_b32 v23, 0xffff0000, v197
    v_mul_f32 v22, s26, v22
    v_mfma_f32_16x16x32_bf16 v[60:63], a[120:123], v[180:183], v[60:63]
    v_mul_f32 v23, s26, v23
    v_cvt_pk_bf16_f32 v197, v22, v23
    v_lshlrev_b32 v1, 16, v198
    v_and_b32 v2, 0xffff0000, v198
    v_mul_f32 v1, s26, v1
    v_mul_f32 v2, s26, v2
    v_cvt_pk_bf16_f32 v198, v1, v2
    v_lshlrev_b32 v22, 16, v199
    v_and_b32 v23, 0xffff0000, v199
    v_mul_f32 v22, s26, v22
    v_mul_f32 v23, s26, v23
    v_cvt_pk_bf16_f32 v199, v22, v23
    v_accvgpr_write_b32 a0, v148
    v_accvgpr_write_b32 a1, v149
    v_mfma_f32_16x16x32_bf16 v[40:43], v[240:243], v[196:199], v[40:43]
    v_accvgpr_write_b32 a2, v150
    v_accvgpr_write_b32 a3, v151
    v_mfma_f32_16x16x32_bf16 v[44:47], a[60:63], v[196:199], v[44:47]
    v_accvgpr_write_b32 a4, v164
    v_accvgpr_write_b32 a5, v165
    v_mfma_f32_16x16x32_bf16 v[56:59], a[108:111], v[196:199], v[56:59]
    v_accvgpr_write_b32 a6, v166
    v_accvgpr_write_b32 a7, v167
    v_mfma_f32_16x16x32_bf16 v[60:63], a[124:127], v[196:199], v[60:63]
    v_max3_f32 v1, v40, v41, v42
    v_accvgpr_write_b32 a8, v180
    v_max3_f32 v1, v43, v44, v1
    v_max3_f32 v1, v45, v46, v1
    v_accvgpr_write_b32 a9, v181
    v_max3_f32 v1, v47, v56, v1
    v_max3_f32 v1, v57, v58, v1
    v_accvgpr_write_b32 a10, v182
    v_max3_f32 v1, v59, v60, v1
    v_max3_f32 v1, v61, v62, v1
    v_max_f32 v1, v63, v1
    v_mov_b32 v2, v1
    v_accvgpr_write_b32 a11, v183
    v_accvgpr_write_b32 a12, v196
    v_permlane16_swap_b32 v2, v1
    v_max_f32 v1, v2, v1
    v_mov_b32 v2, v1
    v_accvgpr_write_b32 a13, v197
    v_accvgpr_write_b32 a14, v198
    v_permlane32_swap_b32 v2, v1
    v_max_f32 v1, v2, v1
    v_add_f32 v1, 0x42400000, v1
    v_sub_f32 v40, v40, v1
    v_sub_f32 v41, v41, v1
    s_add_u32 m0, s21, 122880
    v_sub_f32 v42, v42, v1
    buffer_load_dwordx4 v16, s[8:11], s22 offen nt lds
    buffer_load_dwordx4 v17, s[8:11], s22 offen offset:1024 nt lds
    s_add_u32 s22, s22, 8192
    v_sub_f32 v43, v43, v1
    v_sub_f32 v44, v44, v1
    v_sub_f32 v45, v45, v1
    v_sub_f32 v46, v46, v1
    v_sub_f32 v47, v47, v1
    v_exp_f32 v40, v40
    v_exp_f32 v41, v41
    v_exp_f32 v42, v42
    v_cvt_pk_bf16_f32 v40, v40, v41
    v_exp_f32 v43, v43
    v_exp_f32 v44, v44
    v_cvt_pk_bf16_f32 v41, v42, v43
    v_exp_f32 v45, v45
    v_exp_f32 v46, v46
    v_cvt_pk_bf16_f32 v42, v44, v45
    v_exp_f32 v47, v47
    v_sub_f32 v24, 0, v1
    v_cvt_pk_bf16_f32 v43, v46, v47
    v_sub_f32 v25, 0, v1
    v_sub_f32 v26, 0, v1
    v_sub_f32 v27, 0, v1
    v_sub_f32 v56, v56, v1
    v_sub_f32 v57, v57, v1
    v_sub_f32 v58, v58, v1
    v_sub_f32 v59, v59, v1
    v_sub_f32 v60, v60, v1
    v_sub_f32 v61, v61, v1
    v_sub_f32 v62, v62, v1
    v_sub_f32 v63, v63, v1
    v_exp_f32 v56, v56
    v_exp_f32 v57, v57
    v_exp_f32 v58, v58
    v_cvt_pk_bf16_f32 v56, v56, v57
    v_exp_f32 v59, v59
    v_exp_f32 v60, v60
    v_cvt_pk_bf16_f32 v57, v58, v59
    v_exp_f32 v61, v61
    v_exp_f32 v62, v62
    v_cvt_pk_bf16_f32 v58, v60, v61
    v_exp_f32 v63, v63
    v_accvgpr_write_b32 a15, v199
    v_cvt_pk_bf16_f32 v59, v62, v63
    s_nop 1
    s_waitcnt vmcnt(8)
    s_barrier
    v_mfma_f32_16x16x32_bf16 a[224:227], v[40:43], a[240:243], 0
    ds_read_b64_tr_b16 a[192:193], v8 offset:0
    ds_read_b64_tr_b16 a[194:195], v8 offset:4096
    ds_read_b64_tr_b16 a[196:197], v9 offset:0
    ds_read_b64_tr_b16 a[198:199], v9 offset:4096
    ds_read_b64_tr_b16 a[200:201], v10 offset:0
    ds_read_b64_tr_b16 a[202:203], v10 offset:4096
    ds_read_b64_tr_b16 a[204:205], v11 offset:0
    ds_read_b64_tr_b16 a[206:207], v11 offset:4096
    ds_read_b64_tr_b16 a[208:209], v12 offset:0
    ds_read_b64_tr_b16 a[210:211], v12 offset:4096
    ds_read_b64_tr_b16 a[212:213], v13 offset:0
    ds_read_b64_tr_b16 a[214:215], v13 offset:4096
    ds_read_b64_tr_b16 a[216:217], v14 offset:0
    s_waitcnt lgkmcnt(11)
    v_mfma_f32_16x16x32_bf16 v[136:139], v[40:43], a[192:195], 0
    s_waitcnt lgkmcnt(9)
    ds_read_b64_tr_b16 a[218:219], v14 offset:4096
    ds_read_b64_tr_b16 a[220:221], v15 offset:0
    v_mfma_f32_16x16x32_bf16 v[152:155], v[40:43], a[196:199], 0
    s_waitcnt lgkmcnt(9)
    ds_read_b64_tr_b16 a[222:223], v15 offset:4096
    ds_read_b128 a[64:67], v4 offset:49152
    v_mfma_f32_16x16x32_bf16 v[168:171], v[40:43], a[200:203], 0
    s_waitcnt lgkmcnt(9)
    ds_read_b128 a[80:83], v4 offset:53248
    ds_read_b128 a[68:71], v5 offset:49152
    v_mfma_f32_16x16x32_bf16 v[184:187], v[40:43], a[204:207], 0
    s_waitcnt lgkmcnt(9)
    ds_read_b128 a[84:87], v5 offset:53248
    ds_read_b128 a[72:75], v6 offset:49152
    v_mfma_f32_16x16x32_bf16 v[200:203], v[40:43], a[208:211], 0
    s_waitcnt lgkmcnt(9)
    ds_read_b128 a[88:91], v6 offset:53248
    ds_read_b128 a[76:79], v7 offset:49152
    v_mfma_f32_16x16x32_bf16 v[216:219], v[40:43], a[212:215], 0
    s_waitcnt lgkmcnt(10)
    ds_read_b128 a[92:95], v7 offset:53248
    s_waitcnt lgkmcnt(10)
    v_mfma_f32_16x16x32_bf16 a[244:247], v[40:43], a[216:219], 0
    s_waitcnt lgkmcnt(9)
    s_waitcnt lgkmcnt(8)
    v_mfma_f32_16x16x32_bf16 a[248:251], v[40:43], a[220:223], 0
    s_waitcnt lgkmcnt(7)
    v_mfma_f32_16x16x32_bf16 v[48:51], a[64:67], a[0:3], v[24:27]
    s_waitcnt lgkmcnt(5)
    v_mfma_f32_16x16x32_bf16 v[52:55], a[80:83], a[0:3], v[24:27]
    s_waitcnt lgkmcnt(4)
    v_mfma_f32_16x16x32_bf16 v[48:51], a[68:71], a[4:7], v[48:51]
    s_waitcnt lgkmcnt(3)
    v_mfma_f32_16x16x32_bf16 v[48:51], a[72:75], a[8:11], v[48:51]
    s_waitcnt lgkmcnt(1)
    v_mfma_f32_16x16x32_bf16 v[52:55], a[84:87], a[4:7], v[52:55]
    s_waitcnt lgkmcnt(0)
    v_mfma_f32_16x16x32_bf16 v[48:51], a[76:79], a[12:15], v[48:51]
    s_nop 1
    v_mfma_f32_16x16x32_bf16 v[52:55], a[88:91], a[8:11], v[52:55]
    s_nop 1
    v_mfma_f32_16x16x32_bf16 v[52:55], a[92:95], a[12:15], v[52:55]
    s_nop 1
    v_exp_f32 v48, v48
    v_exp_f32 v49, v49
    v_exp_f32 v50, v50
    v_cvt_pk_bf16_f32 v48, v48, v49
    v_exp_f32 v51, v51
    s_add_u32 m0, s28, 8192
    s_add_u32 s31, s30, 8192
    buffer_load_dwordx4 v16, s[4:7], s31 offen nt lds
    buffer_load_dwordx4 v17, s[4:7], s31 offen offset:1024 nt lds
    buffer_load_dwordx4 v16, s[4:7], s31 offen offset:2048 nt lds
    buffer_load_dwordx4 v17, s[4:7], s31 offen offset:3072 nt lds
    v_cvt_pk_bf16_f32 v49, v50, v51
    v_exp_f32 v52, v52
    v_exp_f32 v53, v53
    v_exp_f32 v54, v54
    v_cvt_pk_bf16_f32 v50, v52, v53
    v_exp_f32 v55, v55
    s_nop 0
    v_cvt_pk_bf16_f32 v51, v54, v55
    s_nop 1
    s_waitcnt vmcnt(8)
    ds_read_b128 v[148:151], v212 offset:4096
    ds_read_b128 v[164:167], v213 offset:4096
    ds_read_b128 v[180:183], v214 offset:4096
    ds_read_b128 v[196:199], v215 offset:4096
    s_waitcnt lgkmcnt(3)
    v_lshlrev_b32 v1, 16, v148
    v_and_b32 v2, 0xffff0000, v148
    v_mul_f32 v1, s26, v1
    v_mul_f32 v2, s26, v2
    v_cvt_pk_bf16_f32 v148, v1, v2
    v_lshlrev_b32 v22, 16, v149
    v_and_b32 v23, 0xffff0000, v149
    v_mul_f32 v22, s26, v22
    v_mul_f32 v23, s26, v23
    v_cvt_pk_bf16_f32 v149, v22, v23
    v_lshlrev_b32 v1, 16, v150
    v_and_b32 v2, 0xffff0000, v150
    v_mul_f32 v1, s26, v1
    v_mul_f32 v2, s26, v2
    v_cvt_pk_bf16_f32 v150, v1, v2
    v_lshlrev_b32 v22, 16, v151
    v_and_b32 v23, 0xffff0000, v151
    v_mul_f32 v22, s26, v22
    v_mul_f32 v23, s26, v23
    v_cvt_pk_bf16_f32 v151, v22, v23
    s_waitcnt lgkmcnt(2)
    v_lshlrev_b32 v1, 16, v164
    v_mfma_f32_16x16x32_bf16 v[64:67], v[120:123], v[148:151], 0
    s_waitcnt lgkmcnt(0)
    v_and_b32 v2, 0xffff0000, v164
    v_mul_f32 v1, s26, v1
    v_mfma_f32_16x16x32_bf16 v[68:71], v[252:255], v[148:151], 0
    v_mul_f32 v2, s26, v2
    v_cvt_pk_bf16_f32 v164, v1, v2
    v_mfma_f32_16x16x32_bf16 v[80:83], a[96:99], v[148:151], 0
    v_lshlrev_b32 v22, 16, v165
    v_and_b32 v23, 0xffff0000, v165
    v_mfma_f32_16x16x32_bf16 v[84:87], a[112:115], v[148:151], 0
    v_mul_f32 v22, s26, v22
    v_mul_f32 v23, s26, v23
    v_cvt_pk_bf16_f32 v165, v22, v23
    v_lshlrev_b32 v1, 16, v166
    v_and_b32 v2, 0xffff0000, v166
    v_mul_f32 v1, s26, v1
    v_mul_f32 v2, s26, v2
    v_cvt_pk_bf16_f32 v166, v1, v2
    v_lshlrev_b32 v22, 16, v167
    v_and_b32 v23, 0xffff0000, v167
    v_mul_f32 v22, s26, v22
    v_mul_f32 v23, s26, v23
    v_cvt_pk_bf16_f32 v167, v22, v23
    v_lshlrev_b32 v1, 16, v180
    v_and_b32 v2, 0xffff0000, v180
    v_mfma_f32_16x16x32_bf16 v[64:67], v[124:127], v[164:167], v[64:67]
    v_mul_f32 v1, s26, v1
    v_mul_f32 v2, s26, v2
    v_mfma_f32_16x16x32_bf16 v[68:71], v[36:39], v[164:167], v[68:71]
    v_cvt_pk_bf16_f32 v180, v1, v2
    v_lshlrev_b32 v22, 16, v181
    v_mfma_f32_16x16x32_bf16 v[80:83], a[100:103], v[164:167], v[80:83]
    v_and_b32 v23, 0xffff0000, v181
    v_mul_f32 v22, s26, v22
    v_mfma_f32_16x16x32_bf16 v[84:87], a[116:119], v[164:167], v[84:87]
    v_mul_f32 v23, s26, v23
    v_cvt_pk_bf16_f32 v181, v22, v23
    v_lshlrev_b32 v1, 16, v182
    v_and_b32 v2, 0xffff0000, v182
    v_mul_f32 v1, s26, v1
    v_mul_f32 v2, s26, v2
    v_cvt_pk_bf16_f32 v182, v1, v2
    v_lshlrev_b32 v22, 16, v183
    v_and_b32 v23, 0xffff0000, v183
    v_mul_f32 v22, s26, v22
    v_mul_f32 v23, s26, v23
    v_cvt_pk_bf16_f32 v183, v22, v23
    v_lshlrev_b32 v1, 16, v196
    v_and_b32 v2, 0xffff0000, v196
    v_mfma_f32_16x16x32_bf16 v[64:67], v[228:231], v[180:183], v[64:67]
    v_mul_f32 v1, s26, v1
    v_mul_f32 v2, s26, v2
    v_mfma_f32_16x16x32_bf16 v[68:71], a[236:239], v[180:183], v[68:71]
    v_cvt_pk_bf16_f32 v196, v1, v2
    v_lshlrev_b32 v22, 16, v197
    v_mfma_f32_16x16x32_bf16 v[80:83], a[104:107], v[180:183], v[80:83]
    v_and_b32 v23, 0xffff0000, v197
    v_mul_f32 v22, s26, v22
    v_mfma_f32_16x16x32_bf16 v[84:87], a[120:123], v[180:183], v[84:87]
    v_mul_f32 v23, s26, v23
    v_cvt_pk_bf16_f32 v197, v22, v23
    v_lshlrev_b32 v1, 16, v198
    v_and_b32 v2, 0xffff0000, v198
    v_mul_f32 v1, s26, v1
    v_mul_f32 v2, s26, v2
    v_cvt_pk_bf16_f32 v198, v1, v2
    v_lshlrev_b32 v22, 16, v199
    v_and_b32 v23, 0xffff0000, v199
    v_mul_f32 v22, s26, v22
    v_mul_f32 v23, s26, v23
    v_cvt_pk_bf16_f32 v199, v22, v23
    v_accvgpr_write_b32 a16, v148
    v_accvgpr_write_b32 a17, v149
    v_mfma_f32_16x16x32_bf16 v[64:67], v[240:243], v[196:199], v[64:67]
    v_accvgpr_write_b32 a18, v150
    v_accvgpr_write_b32 a19, v151
    v_mfma_f32_16x16x32_bf16 v[68:71], a[60:63], v[196:199], v[68:71]
    v_accvgpr_write_b32 a20, v164
    v_accvgpr_write_b32 a21, v165
    v_mfma_f32_16x16x32_bf16 v[80:83], a[108:111], v[196:199], v[80:83]
    v_accvgpr_write_b32 a22, v166
    v_accvgpr_write_b32 a23, v167
    v_mfma_f32_16x16x32_bf16 v[84:87], a[124:127], v[196:199], v[84:87]
    v_max3_f32 v1, v64, v65, v66
    v_accvgpr_write_b32 a24, v180
    v_max3_f32 v1, v67, v68, v1
    v_max3_f32 v1, v69, v70, v1
    v_accvgpr_write_b32 a25, v181
    v_max3_f32 v1, v71, v80, v1
    v_max3_f32 v1, v81, v82, v1
    v_accvgpr_write_b32 a26, v182
    v_max3_f32 v1, v83, v84, v1
    v_max3_f32 v1, v85, v86, v1
    v_max_f32 v1, v87, v1
    v_mov_b32 v2, v1
    v_accvgpr_write_b32 a27, v183
    v_accvgpr_write_b32 a28, v196
    v_permlane16_swap_b32 v2, v1
    v_max_f32 v1, v2, v1
    v_mov_b32 v2, v1
    v_accvgpr_write_b32 a29, v197
    v_accvgpr_write_b32 a30, v198
    v_permlane32_swap_b32 v2, v1
    v_max_f32 v1, v2, v1
    v_add_f32 v1, 0x42400000, v1
    v_sub_f32 v64, v64, v1
    v_sub_f32 v65, v65, v1
    v_sub_f32 v66, v66, v1
    v_sub_f32 v67, v67, v1
    v_sub_f32 v68, v68, v1
    v_sub_f32 v69, v69, v1
    v_sub_f32 v70, v70, v1
    v_sub_f32 v71, v71, v1
    v_exp_f32 v64, v64
    v_exp_f32 v65, v65
    v_exp_f32 v66, v66
    v_cvt_pk_bf16_f32 v64, v64, v65
    v_exp_f32 v67, v67
    v_exp_f32 v68, v68
    v_cvt_pk_bf16_f32 v65, v66, v67
    v_exp_f32 v69, v69
    v_exp_f32 v70, v70
    v_cvt_pk_bf16_f32 v66, v68, v69
    v_exp_f32 v71, v71
    v_sub_f32 v28, 0, v1
    v_cvt_pk_bf16_f32 v67, v70, v71
    v_sub_f32 v29, 0, v1
    v_sub_f32 v30, 0, v1
    v_mfma_f32_16x16x32_bf16 a[228:231], v[64:67], a[240:243], 0
    v_sub_f32 v31, 0, v1
    s_add_u32 m0, s28, 12288
    v_mfma_f32_16x16x32_bf16 v[140:143], v[64:67], a[192:195], 0
    s_add_u32 s31, s30, 12288
    buffer_load_dwordx4 v16, s[4:7], s31 offen nt lds
    v_sub_f32 v80, v80, v1
    v_mfma_f32_16x16x32_bf16 v[156:159], v[64:67], a[196:199], 0
    buffer_load_dwordx4 v17, s[4:7], s31 offen offset:1024 nt lds
    v_sub_f32 v81, v81, v1
    v_mfma_f32_16x16x32_bf16 v[172:175], v[64:67], a[200:203], 0
    buffer_load_dwordx4 v16, s[4:7], s31 offen offset:2048 nt lds
    v_sub_f32 v82, v82, v1
    v_mfma_f32_16x16x32_bf16 v[188:191], v[64:67], a[204:207], 0
    buffer_load_dwordx4 v17, s[4:7], s31 offen offset:3072 nt lds
    v_sub_f32 v83, v83, v1
    v_mfma_f32_16x16x32_bf16 v[204:207], v[64:67], a[208:211], 0
    v_sub_f32 v84, v84, v1
    v_sub_f32 v85, v85, v1
    v_mfma_f32_16x16x32_bf16 v[220:223], v[64:67], a[212:215], 0
    v_sub_f32 v86, v86, v1
    v_sub_f32 v87, v87, v1
    v_mfma_f32_16x16x32_bf16 v[232:235], v[64:67], a[216:219], 0
    v_exp_f32 v80, v80
    v_mfma_f32_16x16x32_bf16 v[244:247], v[64:67], a[220:223], 0
    v_exp_f32 v81, v81
    v_mfma_f32_16x16x32_bf16 v[72:75], a[64:67], a[16:19], v[28:31]
    v_cvt_pk_bf16_f32 v80, v80, v81
    v_accvgpr_write_b32 a31, v199
    v_mfma_f32_16x16x32_bf16 v[72:75], a[68:71], a[20:23], v[72:75]
    v_exp_f32 v82, v82
    v_mfma_f32_16x16x32_bf16 v[72:75], a[72:75], a[24:27], v[72:75]
    v_exp_f32 v83, v83
    v_mfma_f32_16x16x32_bf16 v[72:75], a[76:79], a[28:31], v[72:75]
    v_cvt_pk_bf16_f32 v81, v82, v83
    v_exp_f32 v84, v84
    v_mfma_f32_16x16x32_bf16 v[76:79], a[80:83], a[16:19], v[28:31]
    v_exp_f32 v85, v85
    v_mfma_f32_16x16x32_bf16 v[76:79], a[84:87], a[20:23], v[76:79]
    v_cvt_pk_bf16_f32 v82, v84, v85
    v_exp_f32 v86, v86
    v_mfma_f32_16x16x32_bf16 v[76:79], a[88:91], a[24:27], v[76:79]
    v_exp_f32 v87, v87
    v_mfma_f32_16x16x32_bf16 v[76:79], a[92:95], a[28:31], v[76:79]
    v_cvt_pk_bf16_f32 v83, v86, v87
    v_exp_f32 v72, v72
    v_exp_f32 v73, v73
    v_exp_f32 v74, v74
    v_cvt_pk_bf16_f32 v72, v72, v73
    v_exp_f32 v75, v75
    s_nop 0
    v_cvt_pk_bf16_f32 v73, v74, v75
    v_exp_f32 v76, v76
    v_exp_f32 v77, v77
    v_exp_f32 v78, v78
    v_cvt_pk_bf16_f32 v74, v76, v77
    v_exp_f32 v79, v79
    s_nop 0
    v_cvt_pk_bf16_f32 v75, v78, v79
    s_nop 1
    s_waitcnt vmcnt(8)
    s_barrier
    v_mfma_f32_16x16x32_bf16 a[224:227], v[56:59], a[240:243], a[224:227]
    s_add_u32 m0, s21, 16384
    ds_read_b64_tr_b16 a[128:129], v8 offset:8192
    v_mfma_f32_16x16x32_bf16 a[228:231], v[80:83], a[240:243], a[228:231]
    buffer_load_dwordx4 v20, s[12:15], s23 offen nt lds
    buffer_load_dwordx4 v21, s[12:15], s23 offen offset:1024 nt lds
    s_add_u32 s23, s23, 8192
    ds_read_b64_tr_b16 a[130:131], v8 offset:12288
    ds_read_b64_tr_b16 a[132:133], v9 offset:8192
    ds_read_b64_tr_b16 a[134:135], v9 offset:12288
    ds_read_b64_tr_b16 a[136:137], v10 offset:8192
    ds_read_b64_tr_b16 a[138:139], v10 offset:12288
    ds_read_b64_tr_b16 a[140:141], v11 offset:8192
    ds_read_b64_tr_b16 a[142:143], v11 offset:12288
    ds_read_b64_tr_b16 a[144:145], v12 offset:8192
    ds_read_b64_tr_b16 a[146:147], v12 offset:12288
    ds_read_b64_tr_b16 a[148:149], v13 offset:8192
    ds_read_b64_tr_b16 a[150:151], v13 offset:12288
    ds_read_b64_tr_b16 a[152:153], v14 offset:8192
    s_waitcnt lgkmcnt(11)
    v_mfma_f32_16x16x32_bf16 v[136:139], v[56:59], a[128:131], v[136:139]
    s_waitcnt lgkmcnt(9)
    ds_read_b64_tr_b16 a[154:155], v14 offset:12288
    v_mfma_f32_16x16x32_bf16 v[140:143], v[80:83], a[128:131], v[140:143]
    s_waitcnt lgkmcnt(9)
    ds_read_b64_tr_b16 a[156:157], v15 offset:8192
    v_mfma_f32_16x16x32_bf16 v[152:155], v[56:59], a[132:135], v[152:155]
    s_waitcnt lgkmcnt(9)
    ds_read_b64_tr_b16 a[158:159], v15 offset:12288
    v_mfma_f32_16x16x32_bf16 v[168:171], v[56:59], a[136:139], v[168:171]
    s_waitcnt lgkmcnt(8)
    ds_read_b128 a[160:163], v4 offset:57344
    v_mfma_f32_16x16x32_bf16 v[156:159], v[80:83], a[132:135], v[156:159]
    s_waitcnt lgkmcnt(8)
    ds_read_b128 a[176:179], v4 offset:61440
    v_mfma_f32_16x16x32_bf16 v[184:187], v[56:59], a[140:143], v[184:187]
    s_waitcnt lgkmcnt(8)
    ds_read_b128 a[164:167], v5 offset:57344
    v_mfma_f32_16x16x32_bf16 v[200:203], v[56:59], a[144:147], v[200:203]
    s_waitcnt lgkmcnt(7)
    ds_read_b128 a[180:183], v5 offset:61440
    v_mfma_f32_16x16x32_bf16 v[172:175], v[80:83], a[136:139], v[172:175]
    s_waitcnt lgkmcnt(7)
    ds_read_b128 a[168:171], v6 offset:57344
    v_mfma_f32_16x16x32_bf16 v[216:219], v[56:59], a[148:151], v[216:219]
    ds_read_b128 a[184:187], v6 offset:61440
    v_mfma_f32_16x16x32_bf16 v[188:191], v[80:83], a[140:143], v[188:191]
    s_waitcnt lgkmcnt(8)
    ds_read_b128 a[172:175], v7 offset:57344
    v_mfma_f32_16x16x32_bf16 a[244:247], v[56:59], a[152:155], a[244:247]
    s_waitcnt lgkmcnt(8)
    ds_read_b128 a[188:191], v7 offset:61440
    v_mfma_f32_16x16x32_bf16 v[204:207], v[80:83], a[144:147], v[204:207]
    s_waitcnt lgkmcnt(8)
    v_mfma_f32_16x16x32_bf16 a[248:251], v[56:59], a[156:159], a[248:251]
    s_waitcnt lgkmcnt(7)
    v_mfma_f32_16x16x32_bf16 v[220:223], v[80:83], a[148:151], v[220:223]
    s_waitcnt lgkmcnt(6)
    v_mfma_f32_16x16x32_bf16 v[232:235], v[80:83], a[152:155], v[232:235]
    s_waitcnt lgkmcnt(5)
    v_mfma_f32_16x16x32_bf16 v[244:247], v[80:83], a[156:159], v[244:247]
    s_waitcnt lgkmcnt(4)
    s_add_u32 m0, s21, 98304
    v_mfma_f32_16x16x32_bf16 v[56:59], a[160:163], a[0:3], v[24:27]
    s_waitcnt lgkmcnt(3)
    buffer_load_dwordx4 v16, s[8:11], s22 offen nt lds
    v_mfma_f32_16x16x32_bf16 v[56:59], a[164:167], a[4:7], v[56:59]
    s_waitcnt lgkmcnt(2)
    buffer_load_dwordx4 v17, s[8:11], s22 offen offset:1024 nt lds
    s_add_u32 s22, s22, 8192
    v_mfma_f32_16x16x32_bf16 v[56:59], a[168:171], a[8:11], v[56:59]
    s_waitcnt lgkmcnt(1)
    v_mfma_f32_16x16x32_bf16 v[56:59], a[172:175], a[12:15], v[56:59]
    s_waitcnt lgkmcnt(0)
    v_mfma_f32_16x16x32_bf16 v[60:63], a[176:179], a[0:3], v[24:27]
    v_mfma_f32_16x16x32_bf16 v[60:63], a[180:183], a[4:7], v[60:63]
    v_mfma_f32_16x16x32_bf16 v[60:63], a[184:187], a[8:11], v[60:63]
    v_mfma_f32_16x16x32_bf16 v[60:63], a[188:191], a[12:15], v[60:63]
    v_mfma_f32_16x16x32_bf16 v[80:83], a[160:163], a[16:19], v[28:31]
    v_mfma_f32_16x16x32_bf16 v[80:83], a[164:167], a[20:23], v[80:83]
    v_mfma_f32_16x16x32_bf16 v[80:83], a[168:171], a[24:27], v[80:83]
    v_mfma_f32_16x16x32_bf16 v[80:83], a[172:175], a[28:31], v[80:83]
    v_mfma_f32_16x16x32_bf16 v[84:87], a[176:179], a[16:19], v[28:31]
    v_mfma_f32_16x16x32_bf16 v[84:87], a[180:183], a[20:23], v[84:87]
    v_mfma_f32_16x16x32_bf16 v[84:87], a[184:187], a[24:27], v[84:87]
    v_mfma_f32_16x16x32_bf16 v[84:87], a[188:191], a[28:31], v[84:87]
    s_nop 1
    s_waitcnt vmcnt(8)
    s_add_u32 m0, s21, 24576
    ds_read_b128 v[148:151], v212 offset:8192
    buffer_load_dwordx4 v20, s[12:15], s23 offen nt lds
    buffer_load_dwordx4 v21, s[12:15], s23 offen offset:1024 nt lds
    s_add_u32 s23, s23, 8192
    ds_read_b128 v[164:167], v213 offset:8192
    ds_read_b128 v[180:183], v214 offset:8192
    ds_read_b128 v[196:199], v215 offset:8192
    s_waitcnt lgkmcnt(3)
    v_lshlrev_b32 v1, 16, v148
    v_and_b32 v2, 0xffff0000, v148
    v_mul_f32 v1, s26, v1
    v_mul_f32 v2, s26, v2
    v_cvt_pk_bf16_f32 v148, v1, v2
    v_lshlrev_b32 v22, 16, v149
    v_and_b32 v23, 0xffff0000, v149
    v_mul_f32 v22, s26, v22
    v_mul_f32 v23, s26, v23
    v_cvt_pk_bf16_f32 v149, v22, v23
    v_lshlrev_b32 v1, 16, v150
    v_and_b32 v2, 0xffff0000, v150
    v_mul_f32 v1, s26, v1
    v_mul_f32 v2, s26, v2
    v_cvt_pk_bf16_f32 v150, v1, v2
    v_lshlrev_b32 v22, 16, v151
    v_and_b32 v23, 0xffff0000, v151
    v_mul_f32 v22, s26, v22
    v_mul_f32 v23, s26, v23
    v_cvt_pk_bf16_f32 v151, v22, v23
    s_waitcnt lgkmcnt(2)
    v_lshlrev_b32 v1, 16, v164
    v_mfma_f32_16x16x32_bf16 v[104:107], v[120:123], v[148:151], 0
    s_waitcnt lgkmcnt(0)
    v_and_b32 v2, 0xffff0000, v164
    v_mul_f32 v1, s26, v1
    v_mfma_f32_16x16x32_bf16 v[108:111], v[252:255], v[148:151], 0
    v_mul_f32 v2, s26, v2
    v_cvt_pk_bf16_f32 v164, v1, v2
    v_mfma_f32_16x16x32_bf16 v[88:91], a[96:99], v[148:151], 0
    v_lshlrev_b32 v22, 16, v165
    v_and_b32 v23, 0xffff0000, v165
    v_mfma_f32_16x16x32_bf16 v[92:95], a[112:115], v[148:151], 0
    v_mul_f32 v22, s26, v22
    v_mul_f32 v23, s26, v23
    v_cvt_pk_bf16_f32 v165, v22, v23
    v_lshlrev_b32 v1, 16, v166
    v_and_b32 v2, 0xffff0000, v166
    v_mul_f32 v1, s26, v1
    v_mul_f32 v2, s26, v2
    v_cvt_pk_bf16_f32 v166, v1, v2
    v_lshlrev_b32 v22, 16, v167
    v_and_b32 v23, 0xffff0000, v167
    v_mul_f32 v22, s26, v22
    v_mul_f32 v23, s26, v23
    v_cvt_pk_bf16_f32 v167, v22, v23
    v_lshlrev_b32 v1, 16, v180
    v_and_b32 v2, 0xffff0000, v180
    v_mfma_f32_16x16x32_bf16 v[104:107], v[124:127], v[164:167], v[104:107]
    v_mul_f32 v1, s26, v1
    v_mul_f32 v2, s26, v2
    v_mfma_f32_16x16x32_bf16 v[108:111], v[36:39], v[164:167], v[108:111]
    v_cvt_pk_bf16_f32 v180, v1, v2
    v_lshlrev_b32 v22, 16, v181
    v_mfma_f32_16x16x32_bf16 v[88:91], a[100:103], v[164:167], v[88:91]
    v_and_b32 v23, 0xffff0000, v181
    v_mul_f32 v22, s26, v22
    v_mfma_f32_16x16x32_bf16 v[92:95], a[116:119], v[164:167], v[92:95]
    v_mul_f32 v23, s26, v23
    v_cvt_pk_bf16_f32 v181, v22, v23
    v_lshlrev_b32 v1, 16, v182
    v_and_b32 v2, 0xffff0000, v182
    v_mul_f32 v1, s26, v1
    v_mul_f32 v2, s26, v2
    v_cvt_pk_bf16_f32 v182, v1, v2
    v_lshlrev_b32 v22, 16, v183
    v_and_b32 v23, 0xffff0000, v183
    v_mul_f32 v22, s26, v22
    v_mul_f32 v23, s26, v23
    v_cvt_pk_bf16_f32 v183, v22, v23
    v_lshlrev_b32 v1, 16, v196
    v_and_b32 v2, 0xffff0000, v196
    v_mfma_f32_16x16x32_bf16 v[104:107], v[228:231], v[180:183], v[104:107]
    v_mul_f32 v1, s26, v1
    v_mul_f32 v2, s26, v2
    v_mfma_f32_16x16x32_bf16 v[108:111], a[236:239], v[180:183], v[108:111]
    v_cvt_pk_bf16_f32 v196, v1, v2
    v_lshlrev_b32 v22, 16, v197
    v_mfma_f32_16x16x32_bf16 v[88:91], a[104:107], v[180:183], v[88:91]
    v_and_b32 v23, 0xffff0000, v197
    v_mul_f32 v22, s26, v22
    v_mfma_f32_16x16x32_bf16 v[92:95], a[120:123], v[180:183], v[92:95]
    v_mul_f32 v23, s26, v23
    v_cvt_pk_bf16_f32 v197, v22, v23
    v_lshlrev_b32 v1, 16, v198
    v_and_b32 v2, 0xffff0000, v198
    v_mul_f32 v1, s26, v1
    v_mul_f32 v2, s26, v2
    v_cvt_pk_bf16_f32 v198, v1, v2
    v_lshlrev_b32 v22, 16, v199
    v_and_b32 v23, 0xffff0000, v199
    v_mul_f32 v22, s26, v22
    v_mul_f32 v23, s26, v23
    v_cvt_pk_bf16_f32 v199, v22, v23
    v_accvgpr_write_b32 a32, v148
    v_accvgpr_write_b32 a33, v149
    v_mfma_f32_16x16x32_bf16 v[104:107], v[240:243], v[196:199], v[104:107]
    v_accvgpr_write_b32 a34, v150
    v_accvgpr_write_b32 a35, v151
    v_mfma_f32_16x16x32_bf16 v[108:111], a[60:63], v[196:199], v[108:111]
    v_accvgpr_write_b32 a36, v164
    v_accvgpr_write_b32 a37, v165
    v_mfma_f32_16x16x32_bf16 v[88:91], a[108:111], v[196:199], v[88:91]
    v_accvgpr_write_b32 a38, v166
    v_accvgpr_write_b32 a39, v167
    v_mfma_f32_16x16x32_bf16 v[92:95], a[124:127], v[196:199], v[92:95]
    v_max3_f32 v1, v104, v105, v106
    v_accvgpr_write_b32 a40, v180
    v_max3_f32 v1, v107, v108, v1
    v_max3_f32 v1, v109, v110, v1
    v_accvgpr_write_b32 a41, v181
    v_max3_f32 v1, v111, v88, v1
    v_max3_f32 v1, v89, v90, v1
    v_accvgpr_write_b32 a42, v182
    v_max3_f32 v1, v91, v92, v1
    v_max3_f32 v1, v93, v94, v1
    v_max_f32 v1, v95, v1
    v_mov_b32 v2, v1
    v_accvgpr_write_b32 a43, v183
    v_accvgpr_write_b32 a44, v196
    v_permlane16_swap_b32 v2, v1
    v_max_f32 v1, v2, v1
    v_mov_b32 v2, v1
    v_accvgpr_write_b32 a45, v197
    v_accvgpr_write_b32 a46, v198
    v_permlane32_swap_b32 v2, v1
    v_max_f32 v1, v2, v1
    v_add_f32 v1, 0x42400000, v1
    v_sub_f32 v104, v104, v1
    v_sub_f32 v105, v105, v1
    v_sub_f32 v106, v106, v1
    v_sub_f32 v107, v107, v1
    v_sub_f32 v108, v108, v1
    v_sub_f32 v109, v109, v1
    v_sub_f32 v110, v110, v1
    v_sub_f32 v111, v111, v1
    v_exp_f32 v104, v104
    v_exp_f32 v105, v105
    v_exp_f32 v106, v106
    v_cvt_pk_bf16_f32 v104, v104, v105
    v_exp_f32 v107, v107
    v_exp_f32 v108, v108
    v_cvt_pk_bf16_f32 v105, v106, v107
    v_exp_f32 v109, v109
    v_exp_f32 v110, v110
    v_cvt_pk_bf16_f32 v106, v108, v109
    v_exp_f32 v111, v111
    v_sub_f32 v32, 0, v1
    v_cvt_pk_bf16_f32 v107, v110, v111
    v_sub_f32 v33, 0, v1
    v_sub_f32 v34, 0, v1
    v_mfma_f32_16x16x32_bf16 a[232:235], v[104:107], a[240:243], 0
    v_sub_f32 v35, 0, v1
    v_sub_f32 v88, v88, v1
    v_mfma_f32_16x16x32_bf16 v[144:147], v[104:107], a[192:195], 0
    v_sub_f32 v89, v89, v1
    v_sub_f32 v90, v90, v1
    v_mfma_f32_16x16x32_bf16 v[160:163], v[104:107], a[196:199], 0
    v_sub_f32 v91, v91, v1
    v_sub_f32 v92, v92, v1
    v_mfma_f32_16x16x32_bf16 v[176:179], v[104:107], a[200:203], 0
    v_sub_f32 v93, v93, v1
    s_add_u32 m0, s21, 106496
    v_mfma_f32_16x16x32_bf16 v[192:195], v[104:107], a[204:207], 0
    buffer_load_dwordx4 v16, s[8:11], s22 offen nt lds
    v_sub_f32 v94, v94, v1
    v_mfma_f32_16x16x32_bf16 v[208:211], v[104:107], a[208:211], 0
    buffer_load_dwordx4 v17, s[8:11], s22 offen offset:1024 nt lds
    s_add_u32 s22, s22, 8192
    v_mfma_f32_16x16x32_bf16 v[224:227], v[104:107], a[212:215], 0
    v_sub_f32 v95, v95, v1
    v_accvgpr_write_b32 a47, v199
    v_mfma_f32_16x16x32_bf16 v[236:239], v[104:107], a[216:219], 0
    v_exp_f32 v88, v88
    v_mfma_f32_16x16x32_bf16 v[248:251], v[104:107], a[220:223], 0
    v_exp_f32 v89, v89
    v_mfma_f32_16x16x32_bf16 v[104:107], a[64:67], a[32:35], v[32:35]
    v_cvt_pk_bf16_f32 v88, v88, v89
    v_exp_f32 v90, v90
    v_mfma_f32_16x16x32_bf16 v[104:107], a[68:71], a[36:39], v[104:107]
    v_exp_f32 v91, v91
    v_mfma_f32_16x16x32_bf16 v[104:107], a[72:75], a[40:43], v[104:107]
    v_cvt_pk_bf16_f32 v89, v90, v91
    v_exp_f32 v92, v92
    v_mfma_f32_16x16x32_bf16 v[104:107], a[76:79], a[44:47], v[104:107]
    v_exp_f32 v93, v93
    v_mfma_f32_16x16x32_bf16 v[108:111], a[80:83], a[32:35], v[32:35]
    v_cvt_pk_bf16_f32 v90, v92, v93
    v_exp_f32 v94, v94
    v_mfma_f32_16x16x32_bf16 v[108:111], a[84:87], a[36:39], v[108:111]
    v_exp_f32 v95, v95
    v_mfma_f32_16x16x32_bf16 v[108:111], a[88:91], a[40:43], v[108:111]
    v_cvt_pk_bf16_f32 v91, v94, v95
    v_exp_f32 v104, v104
    v_mfma_f32_16x16x32_bf16 v[108:111], a[92:95], a[44:47], v[108:111]
    v_exp_f32 v105, v105
    v_mfma_f32_16x16x32_bf16 v[96:99], a[160:163], a[32:35], v[32:35]
    v_cvt_pk_bf16_f32 v104, v104, v105
    v_exp_f32 v106, v106
    v_mfma_f32_16x16x32_bf16 v[96:99], a[164:167], a[36:39], v[96:99]
    v_exp_f32 v107, v107
    v_mfma_f32_16x16x32_bf16 v[96:99], a[168:171], a[40:43], v[96:99]
    v_cvt_pk_bf16_f32 v105, v106, v107
    v_exp_f32 v108, v108
    v_mfma_f32_16x16x32_bf16 v[96:99], a[172:175], a[44:47], v[96:99]
    v_exp_f32 v109, v109
    v_mfma_f32_16x16x32_bf16 v[100:103], a[176:179], a[32:35], v[32:35]
    v_cvt_pk_bf16_f32 v106, v108, v109
    v_exp_f32 v110, v110
    v_mfma_f32_16x16x32_bf16 v[100:103], a[180:183], a[36:39], v[100:103]
    v_exp_f32 v111, v111
    v_mfma_f32_16x16x32_bf16 v[100:103], a[184:187], a[40:43], v[100:103]
    v_cvt_pk_bf16_f32 v107, v110, v111
    v_mfma_f32_16x16x32_bf16 v[100:103], a[188:191], a[44:47], v[100:103]
    s_nop 1
    s_waitcnt vmcnt(8)
    s_add_u32 m0, s21, 0
    ds_read_b128 v[148:151], v212 offset:12288
    buffer_load_dwordx4 v20, s[12:15], s23 offen nt lds
    buffer_load_dwordx4 v21, s[12:15], s23 offen offset:1024 nt lds
    s_add_u32 s23, s23, 8192
    ds_read_b128 v[164:167], v213 offset:12288
    ds_read_b128 v[180:183], v214 offset:12288
    ds_read_b128 v[196:199], v215 offset:12288
    s_waitcnt lgkmcnt(3)
    v_lshlrev_b32 v1, 16, v148
    v_and_b32 v2, 0xffff0000, v148
    v_mul_f32 v1, s26, v1
    v_mul_f32 v2, s26, v2
    v_cvt_pk_bf16_f32 v148, v1, v2
    v_lshlrev_b32 v22, 16, v149
    v_and_b32 v23, 0xffff0000, v149
    v_mul_f32 v22, s26, v22
    v_mul_f32 v23, s26, v23
    v_cvt_pk_bf16_f32 v149, v22, v23
    v_lshlrev_b32 v1, 16, v150
    v_and_b32 v2, 0xffff0000, v150
    v_mul_f32 v1, s26, v1
    v_mul_f32 v2, s26, v2
    v_cvt_pk_bf16_f32 v150, v1, v2
    v_lshlrev_b32 v22, 16, v151
    v_and_b32 v23, 0xffff0000, v151
    v_mul_f32 v22, s26, v22
    v_mul_f32 v23, s26, v23
    v_cvt_pk_bf16_f32 v151, v22, v23
    s_waitcnt lgkmcnt(2)
    v_lshlrev_b32 v1, 16, v164
    v_mfma_f32_16x16x32_bf16 v[128:131], v[120:123], v[148:151], 0
    s_waitcnt lgkmcnt(0)
    v_and_b32 v2, 0xffff0000, v164
    v_mul_f32 v1, s26, v1
    v_mfma_f32_16x16x32_bf16 v[132:135], v[252:255], v[148:151], 0
    v_mul_f32 v2, s26, v2
    v_cvt_pk_bf16_f32 v164, v1, v2
    v_mfma_f32_16x16x32_bf16 v[112:115], a[96:99], v[148:151], 0
    v_lshlrev_b32 v22, 16, v165
    v_and_b32 v23, 0xffff0000, v165
    v_mfma_f32_16x16x32_bf16 v[116:119], a[112:115], v[148:151], 0
    v_mul_f32 v22, s26, v22
    v_mul_f32 v23, s26, v23
    v_cvt_pk_bf16_f32 v165, v22, v23
    v_lshlrev_b32 v1, 16, v166
    v_and_b32 v2, 0xffff0000, v166
    v_mul_f32 v1, s26, v1
    v_mul_f32 v2, s26, v2
    v_cvt_pk_bf16_f32 v166, v1, v2
    v_lshlrev_b32 v22, 16, v167
    v_and_b32 v23, 0xffff0000, v167
    v_mul_f32 v22, s26, v22
    v_mul_f32 v23, s26, v23
    v_cvt_pk_bf16_f32 v167, v22, v23
    v_lshlrev_b32 v1, 16, v180
    v_and_b32 v2, 0xffff0000, v180
    v_mfma_f32_16x16x32_bf16 v[128:131], v[124:127], v[164:167], v[128:131]
    v_mul_f32 v1, s26, v1
    v_mul_f32 v2, s26, v2
    v_mfma_f32_16x16x32_bf16 v[132:135], v[36:39], v[164:167], v[132:135]
    v_cvt_pk_bf16_f32 v180, v1, v2
    v_lshlrev_b32 v22, 16, v181
    v_mfma_f32_16x16x32_bf16 v[112:115], a[100:103], v[164:167], v[112:115]
    v_and_b32 v23, 0xffff0000, v181
    v_mul_f32 v22, s26, v22
    v_mfma_f32_16x16x32_bf16 v[116:119], a[116:119], v[164:167], v[116:119]
    v_mul_f32 v23, s26, v23
    v_cvt_pk_bf16_f32 v181, v22, v23
    v_lshlrev_b32 v1, 16, v182
    v_and_b32 v2, 0xffff0000, v182
    v_mul_f32 v1, s26, v1
    v_mul_f32 v2, s26, v2
    v_cvt_pk_bf16_f32 v182, v1, v2
    v_lshlrev_b32 v22, 16, v183
    v_and_b32 v23, 0xffff0000, v183
    v_mul_f32 v22, s26, v22
    v_mul_f32 v23, s26, v23
    v_cvt_pk_bf16_f32 v183, v22, v23
    v_lshlrev_b32 v1, 16, v196
    v_and_b32 v2, 0xffff0000, v196
    v_mfma_f32_16x16x32_bf16 v[128:131], v[228:231], v[180:183], v[128:131]
    v_mul_f32 v1, s26, v1
    v_mul_f32 v2, s26, v2
    v_mfma_f32_16x16x32_bf16 v[132:135], a[236:239], v[180:183], v[132:135]
    v_cvt_pk_bf16_f32 v196, v1, v2
    v_lshlrev_b32 v22, 16, v197
    v_mfma_f32_16x16x32_bf16 v[112:115], a[104:107], v[180:183], v[112:115]
    v_and_b32 v23, 0xffff0000, v197
    v_mul_f32 v22, s26, v22
    v_mfma_f32_16x16x32_bf16 v[116:119], a[120:123], v[180:183], v[116:119]
    v_mul_f32 v23, s26, v23
    v_cvt_pk_bf16_f32 v197, v22, v23
    v_lshlrev_b32 v1, 16, v198
    v_and_b32 v2, 0xffff0000, v198
    v_mul_f32 v1, s26, v1
    v_mul_f32 v2, s26, v2
    v_cvt_pk_bf16_f32 v198, v1, v2
    v_lshlrev_b32 v22, 16, v199
    v_and_b32 v23, 0xffff0000, v199
    v_mul_f32 v22, s26, v22
    v_mul_f32 v23, s26, v23
    v_cvt_pk_bf16_f32 v199, v22, v23
    v_accvgpr_write_b32 a48, v148
    v_accvgpr_write_b32 a49, v149
    v_mfma_f32_16x16x32_bf16 v[128:131], v[240:243], v[196:199], v[128:131]
    v_accvgpr_write_b32 a50, v150
    v_accvgpr_write_b32 a51, v151
    v_mfma_f32_16x16x32_bf16 v[132:135], a[60:63], v[196:199], v[132:135]
    v_accvgpr_write_b32 a52, v164
    v_accvgpr_write_b32 a53, v165
    v_mfma_f32_16x16x32_bf16 v[112:115], a[108:111], v[196:199], v[112:115]
    v_accvgpr_write_b32 a54, v166
    v_accvgpr_write_b32 a55, v167
    v_mfma_f32_16x16x32_bf16 v[116:119], a[124:127], v[196:199], v[116:119]
    v_max3_f32 v1, v128, v129, v130
    v_accvgpr_write_b32 a56, v180
    v_max3_f32 v1, v131, v132, v1
    v_max3_f32 v1, v133, v134, v1
    v_accvgpr_write_b32 a57, v181
    v_max3_f32 v1, v135, v112, v1
    v_max3_f32 v1, v113, v114, v1
    v_accvgpr_write_b32 a58, v182
    v_max3_f32 v1, v115, v116, v1
    v_max3_f32 v1, v117, v118, v1
    v_max_f32 v1, v119, v1
    v_mov_b32 v2, v1
    v_accvgpr_write_b32 a59, v183
    v_accvgpr_write_b32 a60, v196
    v_permlane16_swap_b32 v2, v1
    v_max_f32 v1, v2, v1
    v_mov_b32 v2, v1
    v_accvgpr_write_b32 a61, v197
    v_accvgpr_write_b32 a62, v198
    v_permlane32_swap_b32 v2, v1
    v_max_f32 v1, v2, v1
    v_add_f32 v1, 0x42400000, v1
    v_sub_f32 v128, v128, v1
    v_sub_f32 v129, v129, v1
    v_sub_f32 v130, v130, v1
    v_sub_f32 v131, v131, v1
    v_sub_f32 v132, v132, v1
    v_sub_f32 v133, v133, v1
    v_sub_f32 v134, v134, v1
    v_sub_f32 v135, v135, v1
    v_exp_f32 v128, v128
    v_exp_f32 v129, v129
    v_exp_f32 v130, v130
    v_cvt_pk_bf16_f32 v128, v128, v129
    v_exp_f32 v131, v131
    v_exp_f32 v132, v132
    v_cvt_pk_bf16_f32 v129, v130, v131
    v_exp_f32 v133, v133
    v_exp_f32 v134, v134
    v_cvt_pk_bf16_f32 v130, v132, v133
    v_exp_f32 v135, v135
    v_sub_f32 v36, 0, v1
    v_cvt_pk_bf16_f32 v131, v134, v135
    v_sub_f32 v37, 0, v1
    v_sub_f32 v38, 0, v1
    v_mfma_f32_16x16x32_bf16 a[236:239], v[128:131], a[240:243], 0
    v_sub_f32 v39, 0, v1
    v_sub_f32 v112, v112, v1
    v_mfma_f32_16x16x32_bf16 v[148:151], v[128:131], a[192:195], 0
    v_sub_f32 v113, v113, v1
    v_sub_f32 v114, v114, v1
    v_mfma_f32_16x16x32_bf16 v[164:167], v[128:131], a[196:199], 0
    v_sub_f32 v115, v115, v1
    v_sub_f32 v116, v116, v1
    v_mfma_f32_16x16x32_bf16 v[180:183], v[128:131], a[200:203], 0
    v_sub_f32 v117, v117, v1
    s_add_u32 m0, s21, 114688
    v_mfma_f32_16x16x32_bf16 v[212:215], v[128:131], a[208:211], 0
    buffer_load_dwordx4 v16, s[8:11], s22 offen nt lds
    v_sub_f32 v118, v118, v1
    v_mfma_f32_16x16x32_bf16 v[228:231], v[128:131], a[212:215], 0
    buffer_load_dwordx4 v17, s[8:11], s22 offen offset:1024 nt lds
    s_add_u32 s22, s22, 8192
    v_mfma_f32_16x16x32_bf16 v[240:243], v[128:131], a[216:219], 0
    v_sub_f32 v119, v119, v1
    v_accvgpr_write_b32 a63, v199
    v_mfma_f32_16x16x32_bf16 v[196:199], v[128:131], a[204:207], 0
    v_exp_f32 v112, v112
    v_mfma_f32_16x16x32_bf16 v[252:255], v[128:131], a[220:223], 0
    v_exp_f32 v113, v113
    v_mfma_f32_16x16x32_bf16 v[128:131], a[64:67], a[48:51], v[36:39]
    v_cvt_pk_bf16_f32 v112, v112, v113
    v_exp_f32 v114, v114
    v_mfma_f32_16x16x32_bf16 v[128:131], a[68:71], a[52:55], v[128:131]
    v_exp_f32 v115, v115
    v_mfma_f32_16x16x32_bf16 v[128:131], a[72:75], a[56:59], v[128:131]
    v_cvt_pk_bf16_f32 v113, v114, v115
    v_exp_f32 v116, v116
    v_mfma_f32_16x16x32_bf16 v[128:131], a[76:79], a[60:63], v[128:131]
    v_exp_f32 v117, v117
    v_mfma_f32_16x16x32_bf16 v[132:135], a[80:83], a[48:51], v[36:39]
    v_cvt_pk_bf16_f32 v114, v116, v117
    v_exp_f32 v118, v118
    v_mfma_f32_16x16x32_bf16 v[132:135], a[84:87], a[52:55], v[132:135]
    v_exp_f32 v119, v119
    v_mfma_f32_16x16x32_bf16 v[132:135], a[88:91], a[56:59], v[132:135]
    v_cvt_pk_bf16_f32 v115, v118, v119
    v_exp_f32 v128, v128
    v_mfma_f32_16x16x32_bf16 v[132:135], a[92:95], a[60:63], v[132:135]
    s_waitcnt vmcnt(10)
    s_barrier
    ds_read_b64_tr_b16 a[96:97], v8 offset:16384
    v_exp_f32 v129, v129
    v_mfma_f32_16x16x32_bf16 v[120:123], a[160:163], a[48:51], v[36:39]
    ds_read_b64_tr_b16 a[98:99], v8 offset:20480
    v_cvt_pk_bf16_f32 v128, v128, v129
    v_mfma_f32_16x16x32_bf16 v[120:123], a[164:167], a[52:55], v[120:123]
    ds_read_b64_tr_b16 a[100:101], v9 offset:16384
    v_exp_f32 v130, v130
    v_mfma_f32_16x16x32_bf16 v[120:123], a[168:171], a[56:59], v[120:123]
    ds_read_b64_tr_b16 a[102:103], v9 offset:20480
    v_exp_f32 v131, v131
    v_mfma_f32_16x16x32_bf16 v[120:123], a[172:175], a[60:63], v[120:123]
    ds_read_b64_tr_b16 a[104:105], v10 offset:16384
    v_cvt_pk_bf16_f32 v129, v130, v131
    v_mfma_f32_16x16x32_bf16 v[124:127], a[176:179], a[48:51], v[36:39]
    ds_read_b64_tr_b16 a[106:107], v10 offset:20480
    v_exp_f32 v132, v132
    v_mfma_f32_16x16x32_bf16 v[124:127], a[180:183], a[52:55], v[124:127]
    ds_read_b64_tr_b16 a[108:109], v11 offset:16384
    v_exp_f32 v133, v133
    v_mfma_f32_16x16x32_bf16 v[124:127], a[184:187], a[56:59], v[124:127]
    ds_read_b64_tr_b16 a[110:111], v11 offset:20480
    v_cvt_pk_bf16_f32 v130, v132, v133
    v_mfma_f32_16x16x32_bf16 v[124:127], a[188:191], a[60:63], v[124:127]
    v_exp_f32 v134, v134
    v_exp_f32 v135, v135
    s_nop 0
    v_cvt_pk_bf16_f32 v131, v134, v135
    s_nop 1
    s_waitcnt vmcnt(8)
    s_barrier
    s_mov_b32 s24, 6
    s_add_u32 s32, s8, s22
    s_addc_u32 s33, s9, 0
    s_add_u32 s34, s12, s23
    s_addc_u32 s35, s13, 0
    s_waitcnt lgkmcnt(6)
L_loop:
    v_mfma_f32_16x16x32_bf16 v[144:147], v[88:91], a[128:131], v[144:147]
    v_exp_f32 v56, v56
    v_mfma_f32_16x16x32_bf16 v[144:147], v[104:107], a[96:99], v[144:147]
    s_waitcnt lgkmcnt(4)
    ds_read_b64_tr_b16 a[112:113], v12 offset:16384
    v_mfma_f32_16x16x32_bf16 v[148:151], v[112:115], a[128:131], v[148:151]
    v_exp_f32 v57, v57
    v_mfma_f32_16x16x32_bf16 v[148:151], v[128:131], a[96:99], v[148:151]
    ds_read_b64_tr_b16 a[114:115], v12 offset:20480
    v_cvt_pk_bf16_f32 v56, v56, v57
    v_mfma_f32_16x16x32_bf16 v[160:163], v[88:91], a[132:135], v[160:163]
    v_exp_f32 v58, v58
    v_mfma_f32_16x16x32_bf16 v[160:163], v[104:107], a[100:103], v[160:163]
    s_waitcnt lgkmcnt(4)
    ds_read_b64_tr_b16 a[116:117], v13 offset:16384
    v_mfma_f32_16x16x32_bf16 v[164:167], v[112:115], a[132:135], v[164:167]
    v_exp_f32 v59, v59
    v_mfma_f32_16x16x32_bf16 v[164:167], v[128:131], a[100:103], v[164:167]
    ds_read_b64_tr_b16 a[118:119], v13 offset:20480
    v_cvt_pk_bf16_f32 v57, v58, v59
    v_mfma_f32_16x16x32_bf16 v[176:179], v[88:91], a[136:139], v[176:179]
    v_exp_f32 v80, v80
    v_mfma_f32_16x16x32_bf16 v[176:179], v[104:107], a[104:107], v[176:179]
    ds_read_b64_tr_b16 a[120:121], v14 offset:16384
    v_mfma_f32_16x16x32_bf16 v[180:183], v[112:115], a[136:139], v[180:183]
    v_exp_f32 v81, v81
    v_mfma_f32_16x16x32_bf16 v[180:183], v[128:131], a[104:107], v[180:183]
    ds_read_b64_tr_b16 a[122:123], v14 offset:20480
    v_cvt_pk_bf16_f32 v80, v80, v81
    v_mfma_f32_16x16x32_bf16 a[232:235], v[88:91], a[240:243], a[232:235]
    v_exp_f32 v82, v82
    v_mfma_f32_16x16x32_bf16 a[232:235], v[104:107], a[240:243], a[232:235]
    s_waitcnt lgkmcnt(4)
    ds_read_b64_tr_b16 a[124:125], v15 offset:16384
    v_mfma_f32_16x16x32_bf16 v[192:195], v[88:91], a[140:143], v[192:195]
    v_exp_f32 v83, v83
    v_mfma_f32_16x16x32_bf16 v[192:195], v[104:107], a[108:111], v[192:195]
    ds_read_b64_tr_b16 a[126:127], v15 offset:20480
    v_cvt_pk_bf16_f32 v81, v82, v83
    v_mfma_f32_16x16x32_bf16 v[196:199], v[112:115], a[140:143], v[196:199]
    v_exp_f32 v96, v96
    v_mfma_f32_16x16x32_bf16 v[196:199], v[128:131], a[108:111], v[196:199]
    v_mfma_f32_16x16x32_bf16 v[208:211], v[88:91], a[144:147], v[208:211]
    v_exp_f32 v97, v97
    v_mfma_f32_16x16x32_bf16 v[208:211], v[104:107], a[112:115], v[208:211]
    ds_read_b128 a[64:67], v4 offset:32768
    v_cvt_pk_bf16_f32 v96, v96, v97
    v_mfma_f32_16x16x32_bf16 v[212:215], v[112:115], a[144:147], v[212:215]
    v_exp_f32 v98, v98
    v_mfma_f32_16x16x32_bf16 v[212:215], v[128:131], a[112:115], v[212:215]
    s_waitcnt lgkmcnt(3)
    s_add_u32 m0, s21, 8192
    ds_read_b128 a[68:71], v5 offset:32768
    v_mfma_f32_16x16x32_bf16 v[224:227], v[88:91], a[148:151], v[224:227]
    v_exp_f32 v99, v99
    v_mfma_f32_16x16x32_bf16 v[224:227], v[104:107], a[116:119], v[224:227]
    ds_read_b128 a[72:75], v6 offset:32768
    v_cvt_pk_bf16_f32 v97, v98, v99
    v_mfma_f32_16x16x32_bf16 v[228:231], v[112:115], a[148:151], v[228:231]
    v_exp_f32 v120, v120
    v_mfma_f32_16x16x32_bf16 v[228:231], v[128:131], a[116:119], v[228:231]
    global_load_lds_dwordx4 v20, s[34:35] nt
    v_mfma_f32_16x16x32_bf16 a[236:239], v[112:115], a[240:243], a[236:239]
    v_exp_f32 v121, v121
    v_mfma_f32_16x16x32_bf16 a[236:239], v[128:131], a[240:243], a[236:239]
    ds_read_b128 a[76:79], v7 offset:32768
    v_cvt_pk_bf16_f32 v120, v120, v121
    v_mfma_f32_16x16x32_bf16 v[236:239], v[88:91], a[152:155], v[236:239]
    v_exp_f32 v122, v122
    v_mfma_f32_16x16x32_bf16 v[236:239], v[104:107], a[120:123], v[236:239]
    s_waitcnt lgkmcnt(4)
    ds_read_b128 a[80:83], v4 offset:36864
    v_mfma_f32_16x16x32_bf16 v[240:243], v[112:115], a[152:155], v[240:243]
    v_exp_f32 v123, v123
    v_mfma_f32_16x16x32_bf16 v[240:243], v[128:131], a[120:123], v[240:243]
    ds_read_b128 a[84:87], v5 offset:36864
    v_cvt_pk_bf16_f32 v121, v122, v123
    v_mfma_f32_16x16x32_bf16 v[248:251], v[88:91], a[156:159], v[248:251]
    v_exp_f32 v60, v60
    v_mfma_f32_16x16x32_bf16 v[248:251], v[104:107], a[124:127], v[248:251]
    s_waitcnt lgkmcnt(3)
    global_load_lds_dwordx4 v21, s[34:35] offset:1024 nt
    v_mfma_f32_16x16x32_bf16 v[252:255], v[112:115], a[156:159], v[252:255]
    v_exp_f32 v61, v61
    v_mfma_f32_16x16x32_bf16 v[252:255], v[128:131], a[124:127], v[252:255]
    ds_read_b128 a[88:91], v6 offset:36864
    v_cvt_pk_bf16_f32 v58, v60, v61
    v_mfma_f32_16x16x32_bf16 v[40:43], a[64:67], a[0:3], v[24:27]
    v_exp_f32 v62, v62
    v_mfma_f32_16x16x32_bf16 v[40:43], a[68:71], a[4:7], v[40:43]
    s_waitcnt lgkmcnt(3)
    s_add_u32 m0, s21, 122880
    ds_read_b128 a[92:95], v7 offset:36864
    v_mfma_f32_16x16x32_bf16 v[40:43], a[72:75], a[8:11], v[40:43]
    v_exp_f32 v63, v63
    v_mfma_f32_16x16x32_bf16 v[40:43], a[76:79], a[12:15], v[40:43]
    s_add_u32 s34, s34, 8192
    s_addc_u32 s35, s35, 0
    v_cvt_pk_bf16_f32 v59, v62, v63
    v_mfma_f32_16x16x32_bf16 v[64:67], a[64:67], a[16:19], v[28:31]
    v_exp_f32 v84, v84
    v_mfma_f32_16x16x32_bf16 v[64:67], a[68:71], a[20:23], v[64:67]
    global_load_lds_dwordx4 v16, s[32:33] nt
    v_mfma_f32_16x16x32_bf16 v[64:67], a[72:75], a[24:27], v[64:67]
    v_exp_f32 v85, v85
    v_mfma_f32_16x16x32_bf16 v[64:67], a[76:79], a[28:31], v[64:67]
    v_cvt_pk_bf16_f32 v82, v84, v85
    v_mfma_f32_16x16x32_bf16 v[104:107], a[64:67], a[32:35], v[32:35]
    v_exp_f32 v86, v86
    v_mfma_f32_16x16x32_bf16 v[104:107], a[68:71], a[36:39], v[104:107]
    v_mfma_f32_16x16x32_bf16 v[104:107], a[72:75], a[40:43], v[104:107]
    v_exp_f32 v87, v87
    v_mfma_f32_16x16x32_bf16 v[104:107], a[76:79], a[44:47], v[104:107]
    v_cvt_pk_bf16_f32 v83, v86, v87
    v_mfma_f32_16x16x32_bf16 v[128:131], a[64:67], a[48:51], v[36:39]
    v_exp_f32 v100, v100
    v_mfma_f32_16x16x32_bf16 v[128:131], a[68:71], a[52:55], v[128:131]
    s_waitcnt lgkmcnt(0)
    global_load_lds_dwordx4 v17, s[32:33] offset:1024 nt
    v_mfma_f32_16x16x32_bf16 v[128:131], a[72:75], a[56:59], v[128:131]
    v_exp_f32 v101, v101
    v_mfma_f32_16x16x32_bf16 v[128:131], a[76:79], a[60:63], v[128:131]
    v_cvt_pk_bf16_f32 v98, v100, v101
    v_mfma_f32_16x16x32_bf16 v[44:47], a[80:83], a[0:3], v[24:27]
    v_exp_f32 v102, v102
    v_mfma_f32_16x16x32_bf16 v[44:47], a[84:87], a[4:7], v[44:47]
    s_waitcnt vmcnt(8)
    s_barrier
    v_mfma_f32_16x16x32_bf16 v[44:47], a[88:91], a[8:11], v[44:47]
    v_exp_f32 v103, v103
    v_mfma_f32_16x16x32_bf16 v[44:47], a[92:95], a[12:15], v[44:47]
    ds_read_b64_tr_b16 a[128:129], v8 offset:24576
    v_cvt_pk_bf16_f32 v99, v102, v103
    v_mfma_f32_16x16x32_bf16 v[68:71], a[80:83], a[16:19], v[28:31]
    v_exp_f32 v124, v124
    v_mfma_f32_16x16x32_bf16 v[68:71], a[84:87], a[20:23], v[68:71]
    s_add_u32 s32, s32, 8192
    s_addc_u32 s33, s33, 0
    ds_read_b64_tr_b16 a[130:131], v8 offset:28672
    v_mfma_f32_16x16x32_bf16 v[68:71], a[88:91], a[24:27], v[68:71]
    v_exp_f32 v125, v125
    v_mfma_f32_16x16x32_bf16 v[68:71], a[92:95], a[28:31], v[68:71]
    ds_read_b64_tr_b16 a[132:133], v9 offset:24576
    v_cvt_pk_bf16_f32 v122, v124, v125
    v_mfma_f32_16x16x32_bf16 v[108:111], a[80:83], a[32:35], v[32:35]
    v_exp_f32 v126, v126
    v_mfma_f32_16x16x32_bf16 v[108:111], a[84:87], a[36:39], v[108:111]
    ds_read_b64_tr_b16 a[134:135], v9 offset:28672
    v_mfma_f32_16x16x32_bf16 v[108:111], a[88:91], a[40:43], v[108:111]
    v_exp_f32 v127, v127
    v_mfma_f32_16x16x32_bf16 v[108:111], a[92:95], a[44:47], v[108:111]
    ds_read_b64_tr_b16 a[136:137], v10 offset:24576
    v_cvt_pk_bf16_f32 v123, v126, v127
    v_mfma_f32_16x16x32_bf16 v[132:135], a[80:83], a[48:51], v[36:39]
    ds_read_b64_tr_b16 a[138:139], v10 offset:28672
    v_mfma_f32_16x16x32_bf16 v[132:135], a[84:87], a[52:55], v[132:135]
    ds_read_b64_tr_b16 a[140:141], v11 offset:24576
    v_mfma_f32_16x16x32_bf16 v[132:135], a[88:91], a[56:59], v[132:135]
    ds_read_b64_tr_b16 a[142:143], v11 offset:28672
    v_mfma_f32_16x16x32_bf16 v[132:135], a[92:95], a[60:63], v[132:135]
    s_waitcnt lgkmcnt(6)
    v_mfma_f32_16x16x32_bf16 v[136:139], v[48:51], a[96:99], v[136:139]
    v_exp_f32 v40, v40
    v_mfma_f32_16x16x32_bf16 v[136:139], v[56:59], a[128:131], v[136:139]
    s_waitcnt lgkmcnt(4)
    ds_read_b64_tr_b16 a[144:145], v12 offset:24576
    v_mfma_f32_16x16x32_bf16 v[140:143], v[72:75], a[96:99], v[140:143]
    v_exp_f32 v41, v41
    v_mfma_f32_16x16x32_bf16 v[140:143], v[80:83], a[128:131], v[140:143]
    ds_read_b64_tr_b16 a[146:147], v12 offset:28672
    v_cvt_pk_bf16_f32 v40, v40, v41
    v_mfma_f32_16x16x32_bf16 v[152:155], v[48:51], a[100:103], v[152:155]
    v_exp_f32 v42, v42
    v_mfma_f32_16x16x32_bf16 v[152:155], v[56:59], a[132:135], v[152:155]
    s_waitcnt lgkmcnt(4)
    ds_read_b64_tr_b16 a[148:149], v13 offset:24576
    v_mfma_f32_16x16x32_bf16 v[156:159], v[72:75], a[100:103], v[156:159]
    v_exp_f32 v43, v43
    v_mfma_f32_16x16x32_bf16 v[156:159], v[80:83], a[132:135], v[156:159]
    ds_read_b64_tr_b16 a[150:151], v13 offset:28672
    v_cvt_pk_bf16_f32 v41, v42, v43
    v_mfma_f32_16x16x32_bf16 v[168:171], v[48:51], a[104:107], v[168:171]
    v_exp_f32 v64, v64
    v_mfma_f32_16x16x32_bf16 v[168:171], v[56:59], a[136:139], v[168:171]
    ds_read_b64_tr_b16 a[152:153], v14 offset:24576
    v_mfma_f32_16x16x32_bf16 v[172:175], v[72:75], a[104:107], v[172:175]
    v_exp_f32 v65, v65
    v_mfma_f32_16x16x32_bf16 v[172:175], v[80:83], a[136:139], v[172:175]
    ds_read_b64_tr_b16 a[154:155], v14 offset:28672
    v_cvt_pk_bf16_f32 v64, v64, v65
    v_mfma_f32_16x16x32_bf16 a[224:227], v[48:51], a[240:243], a[224:227]
    v_exp_f32 v66, v66
    v_mfma_f32_16x16x32_bf16 a[224:227], v[56:59], a[240:243], a[224:227]
    s_waitcnt lgkmcnt(4)
    ds_read_b64_tr_b16 a[156:157], v15 offset:24576
    v_mfma_f32_16x16x32_bf16 v[184:187], v[48:51], a[108:111], v[184:187]
    v_exp_f32 v67, v67
    v_mfma_f32_16x16x32_bf16 v[184:187], v[56:59], a[140:143], v[184:187]
    ds_read_b64_tr_b16 a[158:159], v15 offset:28672
    v_cvt_pk_bf16_f32 v65, v66, v67
    v_mfma_f32_16x16x32_bf16 v[188:191], v[72:75], a[108:111], v[188:191]
    v_exp_f32 v104, v104
    v_mfma_f32_16x16x32_bf16 v[188:191], v[80:83], a[140:143], v[188:191]
    v_mfma_f32_16x16x32_bf16 v[200:203], v[48:51], a[112:115], v[200:203]
    v_exp_f32 v105, v105
    v_mfma_f32_16x16x32_bf16 v[200:203], v[56:59], a[144:147], v[200:203]
    ds_read_b128 a[64:67], v4 offset:40960
    v_cvt_pk_bf16_f32 v104, v104, v105
    v_mfma_f32_16x16x32_bf16 v[204:207], v[72:75], a[112:115], v[204:207]
    v_exp_f32 v106, v106
    v_mfma_f32_16x16x32_bf16 v[204:207], v[80:83], a[144:147], v[204:207]
    s_waitcnt lgkmcnt(3)
    s_add_u32 m0, s21, 16384
    ds_read_b128 a[68:71], v5 offset:40960
    v_mfma_f32_16x16x32_bf16 v[216:219], v[48:51], a[116:119], v[216:219]
    v_exp_f32 v107, v107
    v_mfma_f32_16x16x32_bf16 v[216:219], v[56:59], a[148:151], v[216:219]
    ds_read_b128 a[72:75], v6 offset:40960
    v_cvt_pk_bf16_f32 v105, v106, v107
    v_mfma_f32_16x16x32_bf16 v[220:223], v[72:75], a[116:119], v[220:223]
    v_exp_f32 v128, v128
    v_mfma_f32_16x16x32_bf16 v[220:223], v[80:83], a[148:151], v[220:223]
    global_load_lds_dwordx4 v20, s[34:35] nt
    v_mfma_f32_16x16x32_bf16 a[228:231], v[72:75], a[240:243], a[228:231]
    v_exp_f32 v129, v129
    v_mfma_f32_16x16x32_bf16 a[228:231], v[80:83], a[240:243], a[228:231]
    ds_read_b128 a[76:79], v7 offset:40960
    v_cvt_pk_bf16_f32 v128, v128, v129
    v_mfma_f32_16x16x32_bf16 a[244:247], v[48:51], a[120:123], a[244:247]
    v_exp_f32 v130, v130
    v_mfma_f32_16x16x32_bf16 a[244:247], v[56:59], a[152:155], a[244:247]
    s_waitcnt lgkmcnt(4)
    ds_read_b128 a[80:83], v4 offset:45056
    v_mfma_f32_16x16x32_bf16 v[232:235], v[72:75], a[120:123], v[232:235]
    v_exp_f32 v131, v131
    v_mfma_f32_16x16x32_bf16 v[232:235], v[80:83], a[152:155], v[232:235]
    ds_read_b128 a[84:87], v5 offset:45056
    v_cvt_pk_bf16_f32 v129, v130, v131
    v_mfma_f32_16x16x32_bf16 a[248:251], v[48:51], a[124:127], a[248:251]
    v_exp_f32 v44, v44
    v_mfma_f32_16x16x32_bf16 a[248:251], v[56:59], a[156:159], a[248:251]
    s_waitcnt lgkmcnt(3)
    global_load_lds_dwordx4 v21, s[34:35] offset:1024 nt
    v_mfma_f32_16x16x32_bf16 v[244:247], v[72:75], a[124:127], v[244:247]
    v_exp_f32 v45, v45
    v_mfma_f32_16x16x32_bf16 v[244:247], v[80:83], a[156:159], v[244:247]
    ds_read_b128 a[88:91], v6 offset:45056
    v_cvt_pk_bf16_f32 v42, v44, v45
    v_mfma_f32_16x16x32_bf16 v[56:59], a[64:67], a[0:3], v[24:27]
    v_exp_f32 v46, v46
    v_mfma_f32_16x16x32_bf16 v[56:59], a[68:71], a[4:7], v[56:59]
    s_waitcnt lgkmcnt(3)
    s_add_u32 m0, s21, 98304
    ds_read_b128 a[92:95], v7 offset:45056
    v_mfma_f32_16x16x32_bf16 v[56:59], a[72:75], a[8:11], v[56:59]
    v_exp_f32 v47, v47
    v_mfma_f32_16x16x32_bf16 v[56:59], a[76:79], a[12:15], v[56:59]
    s_add_u32 s34, s34, 8192
    s_addc_u32 s35, s35, 0
    v_cvt_pk_bf16_f32 v43, v46, v47
    v_mfma_f32_16x16x32_bf16 v[80:83], a[64:67], a[16:19], v[28:31]
    v_exp_f32 v68, v68
    v_mfma_f32_16x16x32_bf16 v[80:83], a[68:71], a[20:23], v[80:83]
    global_load_lds_dwordx4 v16, s[32:33] nt
    v_mfma_f32_16x16x32_bf16 v[80:83], a[72:75], a[24:27], v[80:83]
    v_exp_f32 v69, v69
    v_mfma_f32_16x16x32_bf16 v[80:83], a[76:79], a[28:31], v[80:83]
    global_load_lds_dwordx4 v17, s[32:33] offset:1024 nt
    v_cvt_pk_bf16_f32 v66, v68, v69
    v_mfma_f32_16x16x32_bf16 v[88:91], a[64:67], a[32:35], v[32:35]
    v_exp_f32 v70, v70
    v_mfma_f32_16x16x32_bf16 v[88:91], a[68:71], a[36:39], v[88:91]
    s_mov_b32 m0, s69
    v_mfma_f32_16x16x32_bf16 v[88:91], a[72:75], a[40:43], v[88:91]
    v_exp_f32 v71, v71
    v_mfma_f32_16x16x32_bf16 v[88:91], a[76:79], a[44:47], v[88:91]
    v_cvt_pk_bf16_f32 v67, v70, v71
    v_mfma_f32_16x16x32_bf16 v[112:115], a[64:67], a[48:51], v[36:39]
    v_exp_f32 v108, v108
    v_mfma_f32_16x16x32_bf16 v[112:115], a[68:71], a[52:55], v[112:115]
    s_waitcnt lgkmcnt(0)
    buffer_load_dwordx4 v3, s[64:67], s68 offen nt lds
    v_mfma_f32_16x16x32_bf16 v[112:115], a[72:75], a[56:59], v[112:115]
    v_exp_f32 v109, v109
    v_mfma_f32_16x16x32_bf16 v[112:115], a[76:79], a[60:63], v[112:115]
    buffer_load_dwordx4 v18, s[64:67], s68 offen offset:1024 nt lds
    v_cvt_pk_bf16_f32 v106, v108, v109
    v_mfma_f32_16x16x32_bf16 v[60:63], a[80:83], a[0:3], v[24:27]
    v_exp_f32 v110, v110
    v_mfma_f32_16x16x32_bf16 v[60:63], a[84:87], a[4:7], v[60:63]
    s_waitcnt vmcnt(10)
    s_barrier
    v_mfma_f32_16x16x32_bf16 v[60:63], a[88:91], a[8:11], v[60:63]
    v_exp_f32 v111, v111
    v_mfma_f32_16x16x32_bf16 v[60:63], a[92:95], a[12:15], v[60:63]
    ds_read_b64_tr_b16 a[96:97], v8 offset:0
    v_cvt_pk_bf16_f32 v107, v110, v111
    v_mfma_f32_16x16x32_bf16 v[84:87], a[80:83], a[16:19], v[28:31]
    v_exp_f32 v132, v132
    v_mfma_f32_16x16x32_bf16 v[84:87], a[84:87], a[20:23], v[84:87]
    s_add_u32 s32, s32, 8192
    s_addc_u32 s33, s33, 0
    ds_read_b64_tr_b16 a[98:99], v8 offset:4096
    v_mfma_f32_16x16x32_bf16 v[84:87], a[88:91], a[24:27], v[84:87]
    v_exp_f32 v133, v133
    v_mfma_f32_16x16x32_bf16 v[84:87], a[92:95], a[28:31], v[84:87]
    ds_read_b64_tr_b16 a[100:101], v9 offset:0
    v_cvt_pk_bf16_f32 v130, v132, v133
    v_mfma_f32_16x16x32_bf16 v[92:95], a[80:83], a[32:35], v[32:35]
    v_exp_f32 v134, v134
    v_mfma_f32_16x16x32_bf16 v[92:95], a[84:87], a[36:39], v[92:95]
    ds_read_b64_tr_b16 a[102:103], v9 offset:4096
    v_mfma_f32_16x16x32_bf16 v[92:95], a[88:91], a[40:43], v[92:95]
    v_exp_f32 v135, v135
    v_mfma_f32_16x16x32_bf16 v[92:95], a[92:95], a[44:47], v[92:95]
    ds_read_b64_tr_b16 a[104:105], v10 offset:0
    v_cvt_pk_bf16_f32 v131, v134, v135
    v_mfma_f32_16x16x32_bf16 v[116:119], a[80:83], a[48:51], v[36:39]
    ds_read_b64_tr_b16 a[106:107], v10 offset:4096
    v_mfma_f32_16x16x32_bf16 v[116:119], a[84:87], a[52:55], v[116:119]
    ds_read_b64_tr_b16 a[108:109], v11 offset:0
    v_mfma_f32_16x16x32_bf16 v[116:119], a[88:91], a[56:59], v[116:119]
    ds_read_b64_tr_b16 a[110:111], v11 offset:4096
    v_mfma_f32_16x16x32_bf16 v[116:119], a[92:95], a[60:63], v[116:119]
    s_waitcnt lgkmcnt(6)
    v_mfma_f32_16x16x32_bf16 v[144:147], v[96:99], a[128:131], v[144:147]
    v_exp_f32 v56, v56
    v_mfma_f32_16x16x32_bf16 v[144:147], v[104:107], a[96:99], v[144:147]
    s_waitcnt lgkmcnt(4)
    ds_read_b64_tr_b16 a[112:113], v12 offset:0
    v_mfma_f32_16x16x32_bf16 v[148:151], v[120:123], a[128:131], v[148:151]
    s_add_u32 s68, s68, 8192
    v_exp_f32 v57, v57
    v_mfma_f32_16x16x32_bf16 v[148:151], v[128:131], a[96:99], v[148:151]
    ds_read_b64_tr_b16 a[114:115], v12 offset:4096
    v_cvt_pk_bf16_f32 v56, v56, v57
    v_mfma_f32_16x16x32_bf16 v[160:163], v[96:99], a[132:135], v[160:163]
    s_add_u32 s69, s69, 8192
    v_exp_f32 v58, v58
    v_mfma_f32_16x16x32_bf16 v[160:163], v[104:107], a[100:103], v[160:163]
    s_waitcnt lgkmcnt(4)
    ds_read_b64_tr_b16 a[116:117], v13 offset:0
    v_mfma_f32_16x16x32_bf16 v[164:167], v[120:123], a[132:135], v[164:167]
    s_add_u32 s60, s60, 1
    v_exp_f32 v59, v59
    v_mfma_f32_16x16x32_bf16 v[164:167], v[128:131], a[100:103], v[164:167]
    ds_read_b64_tr_b16 a[118:119], v13 offset:4096
    v_cvt_pk_bf16_f32 v57, v58, v59
    v_mfma_f32_16x16x32_bf16 v[176:179], v[96:99], a[136:139], v[176:179]
    s_cmp_eq_u32 s60, 3
    v_exp_f32 v80, v80
    v_mfma_f32_16x16x32_bf16 v[176:179], v[104:107], a[104:107], v[176:179]
    s_cselect_b32 s68, 253952, s68
    ds_read_b64_tr_b16 a[120:121], v14 offset:0
    v_mfma_f32_16x16x32_bf16 v[180:183], v[120:123], a[136:139], v[180:183]
    s_cselect_b32 s69, s71, s69
    v_exp_f32 v81, v81
    v_mfma_f32_16x16x32_bf16 v[180:183], v[128:131], a[104:107], v[180:183]
    ds_read_b64_tr_b16 a[122:123], v14 offset:4096
    v_cvt_pk_bf16_f32 v80, v80, v81
    v_mfma_f32_16x16x32_bf16 a[232:235], v[96:99], a[240:243], a[232:235]
    s_cselect_b32 s64, s8, s64
    v_exp_f32 v82, v82
    v_mfma_f32_16x16x32_bf16 a[232:235], v[104:107], a[240:243], a[232:235]
    s_waitcnt lgkmcnt(4)
    ds_read_b64_tr_b16 a[124:125], v15 offset:0
    v_mfma_f32_16x16x32_bf16 v[192:195], v[96:99], a[140:143], v[192:195]
    s_cselect_b32 s65, s9, s65
    v_exp_f32 v83, v83
    v_mfma_f32_16x16x32_bf16 v[192:195], v[104:107], a[108:111], v[192:195]
    ds_read_b64_tr_b16 a[126:127], v15 offset:4096
    v_cvt_pk_bf16_f32 v81, v82, v83
    v_mfma_f32_16x16x32_bf16 v[196:199], v[120:123], a[140:143], v[196:199]
    s_cselect_b64 s[62:63], -1, 0
    v_exp_f32 v88, v88
    v_mfma_f32_16x16x32_bf16 v[196:199], v[128:131], a[108:111], v[196:199]
    s_cmp_ge_u32 s60, 4
    v_mfma_f32_16x16x32_bf16 v[208:211], v[96:99], a[144:147], v[208:211]
    s_cselect_b32 s69, s59, s69
    v_exp_f32 v89, v89
    v_mfma_f32_16x16x32_bf16 v[208:211], v[104:107], a[112:115], v[208:211]
    ds_read_b128 a[64:67], v4 offset:49152
    v_cvt_pk_bf16_f32 v88, v88, v89
    v_mfma_f32_16x16x32_bf16 v[212:215], v[120:123], a[144:147], v[212:215]
    v_exp_f32 v90, v90
    v_mfma_f32_16x16x32_bf16 v[212:215], v[128:131], a[112:115], v[212:215]
    s_waitcnt lgkmcnt(3)
    s_add_u32 m0, s21, 24576
    ds_read_b128 a[68:71], v5 offset:49152
    v_mfma_f32_16x16x32_bf16 v[224:227], v[96:99], a[148:151], v[224:227]
    v_exp_f32 v91, v91
    v_mfma_f32_16x16x32_bf16 v[224:227], v[104:107], a[116:119], v[224:227]
    ds_read_b128 a[72:75], v6 offset:49152
    v_cvt_pk_bf16_f32 v89, v90, v91
    v_mfma_f32_16x16x32_bf16 v[228:231], v[120:123], a[148:151], v[228:231]
    v_exp_f32 v112, v112
    v_mfma_f32_16x16x32_bf16 v[228:231], v[128:131], a[116:119], v[228:231]
    global_load_lds_dwordx4 v20, s[34:35] nt
    v_mfma_f32_16x16x32_bf16 a[236:239], v[120:123], a[240:243], a[236:239]
    v_exp_f32 v113, v113
    v_mfma_f32_16x16x32_bf16 a[236:239], v[128:131], a[240:243], a[236:239]
    ds_read_b128 a[76:79], v7 offset:49152
    v_cvt_pk_bf16_f32 v112, v112, v113
    v_mfma_f32_16x16x32_bf16 v[236:239], v[96:99], a[152:155], v[236:239]
    v_exp_f32 v114, v114
    v_mfma_f32_16x16x32_bf16 v[236:239], v[104:107], a[120:123], v[236:239]
    s_waitcnt lgkmcnt(4)
    ds_read_b128 a[80:83], v4 offset:53248
    v_mfma_f32_16x16x32_bf16 v[240:243], v[120:123], a[152:155], v[240:243]
    v_exp_f32 v115, v115
    v_mfma_f32_16x16x32_bf16 v[240:243], v[128:131], a[120:123], v[240:243]
    ds_read_b128 a[84:87], v5 offset:53248
    v_cvt_pk_bf16_f32 v113, v114, v115
    v_mfma_f32_16x16x32_bf16 v[248:251], v[96:99], a[156:159], v[248:251]
    v_exp_f32 v60, v60
    v_mfma_f32_16x16x32_bf16 v[248:251], v[104:107], a[124:127], v[248:251]
    s_waitcnt lgkmcnt(3)
    global_load_lds_dwordx4 v21, s[34:35] offset:1024 nt
    v_mfma_f32_16x16x32_bf16 v[252:255], v[120:123], a[156:159], v[252:255]
    v_exp_f32 v61, v61
    v_mfma_f32_16x16x32_bf16 v[252:255], v[128:131], a[124:127], v[252:255]
    ds_read_b128 a[88:91], v6 offset:53248
    v_cvt_pk_bf16_f32 v58, v60, v61
    v_mfma_f32_16x16x32_bf16 v[48:51], a[64:67], a[0:3], v[24:27]
    v_exp_f32 v62, v62
    v_mfma_f32_16x16x32_bf16 v[48:51], a[68:71], a[4:7], v[48:51]
    s_waitcnt lgkmcnt(3)
    s_add_u32 m0, s21, 106496
    ds_read_b128 a[92:95], v7 offset:53248
    v_mfma_f32_16x16x32_bf16 v[48:51], a[72:75], a[8:11], v[48:51]
    v_exp_f32 v63, v63
    v_mfma_f32_16x16x32_bf16 v[48:51], a[76:79], a[12:15], v[48:51]
    s_add_u32 s34, s34, 8192
    s_addc_u32 s35, s35, 0
    v_cvt_pk_bf16_f32 v59, v62, v63
    v_mfma_f32_16x16x32_bf16 v[72:75], a[64:67], a[16:19], v[28:31]
    v_exp_f32 v84, v84
    v_mfma_f32_16x16x32_bf16 v[72:75], a[68:71], a[20:23], v[72:75]
    global_load_lds_dwordx4 v16, s[32:33] nt
    v_mfma_f32_16x16x32_bf16 v[72:75], a[72:75], a[24:27], v[72:75]
    v_exp_f32 v85, v85
    v_mfma_f32_16x16x32_bf16 v[72:75], a[76:79], a[28:31], v[72:75]
    v_cvt_pk_bf16_f32 v82, v84, v85
    v_mfma_f32_16x16x32_bf16 v[104:107], a[64:67], a[32:35], v[32:35]
    v_exp_f32 v86, v86
    v_mfma_f32_16x16x32_bf16 v[104:107], a[68:71], a[36:39], v[104:107]
    v_cndmask_b32 v3, v3, v16, s[62:63]
    v_mfma_f32_16x16x32_bf16 v[104:107], a[72:75], a[40:43], v[104:107]
    v_exp_f32 v87, v87
    v_mfma_f32_16x16x32_bf16 v[104:107], a[76:79], a[44:47], v[104:107]
    v_cvt_pk_bf16_f32 v83, v86, v87
    v_mfma_f32_16x16x32_bf16 v[128:131], a[64:67], a[48:51], v[36:39]
    v_exp_f32 v92, v92
    v_mfma_f32_16x16x32_bf16 v[128:131], a[68:71], a[52:55], v[128:131]
    s_waitcnt lgkmcnt(0)
    global_load_lds_dwordx4 v17, s[32:33] offset:1024 nt
    v_mfma_f32_16x16x32_bf16 v[128:131], a[72:75], a[56:59], v[128:131]
    v_exp_f32 v93, v93
    v_mfma_f32_16x16x32_bf16 v[128:131], a[76:79], a[60:63], v[128:131]
    v_cvt_pk_bf16_f32 v90, v92, v93
    v_mfma_f32_16x16x32_bf16 v[52:55], a[80:83], a[0:3], v[24:27]
    v_exp_f32 v94, v94
    v_mfma_f32_16x16x32_bf16 v[52:55], a[84:87], a[4:7], v[52:55]
    s_waitcnt vmcnt(10)
    s_barrier
    v_mfma_f32_16x16x32_bf16 v[52:55], a[88:91], a[8:11], v[52:55]
    v_exp_f32 v95, v95
    v_mfma_f32_16x16x32_bf16 v[52:55], a[92:95], a[12:15], v[52:55]
    ds_read_b64_tr_b16 a[128:129], v8 offset:8192
    v_cvt_pk_bf16_f32 v91, v94, v95
    v_mfma_f32_16x16x32_bf16 v[76:79], a[80:83], a[16:19], v[28:31]
    v_exp_f32 v116, v116
    v_mfma_f32_16x16x32_bf16 v[76:79], a[84:87], a[20:23], v[76:79]
    s_add_u32 s32, s32, 8192
    s_addc_u32 s33, s33, 0
    ds_read_b64_tr_b16 a[130:131], v8 offset:12288
    v_mfma_f32_16x16x32_bf16 v[76:79], a[88:91], a[24:27], v[76:79]
    v_exp_f32 v117, v117
    v_mfma_f32_16x16x32_bf16 v[76:79], a[92:95], a[28:31], v[76:79]
    ds_read_b64_tr_b16 a[132:133], v9 offset:8192
    v_cvt_pk_bf16_f32 v114, v116, v117
    v_mfma_f32_16x16x32_bf16 v[108:111], a[80:83], a[32:35], v[32:35]
    v_exp_f32 v118, v118
    v_mfma_f32_16x16x32_bf16 v[108:111], a[84:87], a[36:39], v[108:111]
    ds_read_b64_tr_b16 a[134:135], v9 offset:12288
    v_cndmask_b32 v18, v18, v17, s[62:63]
    v_mfma_f32_16x16x32_bf16 v[108:111], a[88:91], a[40:43], v[108:111]
    v_exp_f32 v119, v119
    v_mfma_f32_16x16x32_bf16 v[108:111], a[92:95], a[44:47], v[108:111]
    ds_read_b64_tr_b16 a[136:137], v10 offset:8192
    v_cvt_pk_bf16_f32 v115, v118, v119
    v_mfma_f32_16x16x32_bf16 v[132:135], a[80:83], a[48:51], v[36:39]
    ds_read_b64_tr_b16 a[138:139], v10 offset:12288
    v_mfma_f32_16x16x32_bf16 v[132:135], a[84:87], a[52:55], v[132:135]
    ds_read_b64_tr_b16 a[140:141], v11 offset:8192
    v_mfma_f32_16x16x32_bf16 v[132:135], a[88:91], a[56:59], v[132:135]
    ds_read_b64_tr_b16 a[142:143], v11 offset:12288
    v_mfma_f32_16x16x32_bf16 v[132:135], a[92:95], a[60:63], v[132:135]
    s_waitcnt lgkmcnt(6)
    v_mfma_f32_16x16x32_bf16 v[136:139], v[40:43], a[96:99], v[136:139]
    v_exp_f32 v48, v48
    v_mfma_f32_16x16x32_bf16 v[136:139], v[56:59], a[128:131], v[136:139]
    s_waitcnt lgkmcnt(4)
    ds_read_b64_tr_b16 a[144:145], v12 offset:8192
    v_mfma_f32_16x16x32_bf16 v[140:143], v[64:67], a[96:99], v[140:143]
    v_exp_f32 v49, v49
    v_mfma_f32_16x16x32_bf16 v[140:143], v[80:83], a[128:131], v[140:143]
    ds_read_b64_tr_b16 a[146:147], v12 offset:12288
    v_cvt_pk_bf16_f32 v48, v48, v49
    v_mfma_f32_16x16x32_bf16 v[152:155], v[40:43], a[100:103], v[152:155]
    v_exp_f32 v50, v50
    v_mfma_f32_16x16x32_bf16 v[152:155], v[56:59], a[132:135], v[152:155]
    s_waitcnt lgkmcnt(4)
    ds_read_b64_tr_b16 a[148:149], v13 offset:8192
    v_mfma_f32_16x16x32_bf16 v[156:159], v[64:67], a[100:103], v[156:159]
    v_exp_f32 v51, v51
    v_mfma_f32_16x16x32_bf16 v[156:159], v[80:83], a[132:135], v[156:159]
    ds_read_b64_tr_b16 a[150:151], v13 offset:12288
    v_cvt_pk_bf16_f32 v49, v50, v51
    v_mfma_f32_16x16x32_bf16 v[168:171], v[40:43], a[104:107], v[168:171]
    v_exp_f32 v72, v72
    v_mfma_f32_16x16x32_bf16 v[168:171], v[56:59], a[136:139], v[168:171]
    ds_read_b64_tr_b16 a[152:153], v14 offset:8192
    v_mfma_f32_16x16x32_bf16 v[172:175], v[64:67], a[104:107], v[172:175]
    v_exp_f32 v73, v73
    v_mfma_f32_16x16x32_bf16 v[172:175], v[80:83], a[136:139], v[172:175]
    ds_read_b64_tr_b16 a[154:155], v14 offset:12288
    v_cvt_pk_bf16_f32 v72, v72, v73
    v_mfma_f32_16x16x32_bf16 a[224:227], v[40:43], a[240:243], a[224:227]
    v_exp_f32 v74, v74
    v_mfma_f32_16x16x32_bf16 a[224:227], v[56:59], a[240:243], a[224:227]
    s_waitcnt lgkmcnt(4)
    ds_read_b64_tr_b16 a[156:157], v15 offset:8192
    v_mfma_f32_16x16x32_bf16 v[184:187], v[40:43], a[108:111], v[184:187]
    v_exp_f32 v75, v75
    v_mfma_f32_16x16x32_bf16 v[184:187], v[56:59], a[140:143], v[184:187]
    ds_read_b64_tr_b16 a[158:159], v15 offset:12288
    v_cvt_pk_bf16_f32 v73, v74, v75
    v_mfma_f32_16x16x32_bf16 v[188:191], v[64:67], a[108:111], v[188:191]
    v_exp_f32 v104, v104
    v_mfma_f32_16x16x32_bf16 v[188:191], v[80:83], a[140:143], v[188:191]
    v_mfma_f32_16x16x32_bf16 v[200:203], v[40:43], a[112:115], v[200:203]
    v_exp_f32 v105, v105
    v_mfma_f32_16x16x32_bf16 v[200:203], v[56:59], a[144:147], v[200:203]
    ds_read_b128 a[64:67], v4 offset:57344
    v_cvt_pk_bf16_f32 v104, v104, v105
    v_mfma_f32_16x16x32_bf16 v[204:207], v[64:67], a[112:115], v[204:207]
    v_exp_f32 v106, v106
    v_mfma_f32_16x16x32_bf16 v[204:207], v[80:83], a[144:147], v[204:207]
    s_waitcnt lgkmcnt(3)
    s_add_u32 m0, s21, 0
    ds_read_b128 a[68:71], v5 offset:57344
    v_mfma_f32_16x16x32_bf16 v[216:219], v[40:43], a[116:119], v[216:219]
    v_exp_f32 v107, v107
    v_mfma_f32_16x16x32_bf16 v[216:219], v[56:59], a[148:151], v[216:219]
    ds_read_b128 a[72:75], v6 offset:57344
    v_cvt_pk_bf16_f32 v105, v106, v107
    v_mfma_f32_16x16x32_bf16 v[220:223], v[64:67], a[116:119], v[220:223]
    v_exp_f32 v128, v128
    v_mfma_f32_16x16x32_bf16 v[220:223], v[80:83], a[148:151], v[220:223]
    global_load_lds_dwordx4 v20, s[34:35] nt
    v_mfma_f32_16x16x32_bf16 a[228:231], v[64:67], a[240:243], a[228:231]
    v_exp_f32 v129, v129
    v_mfma_f32_16x16x32_bf16 a[228:231], v[80:83], a[240:243], a[228:231]
    ds_read_b128 a[76:79], v7 offset:57344
    v_cvt_pk_bf16_f32 v128, v128, v129
    v_mfma_f32_16x16x32_bf16 a[244:247], v[40:43], a[120:123], a[244:247]
    v_exp_f32 v130, v130
    v_mfma_f32_16x16x32_bf16 a[244:247], v[56:59], a[152:155], a[244:247]
    s_waitcnt lgkmcnt(4)
    ds_read_b128 a[80:83], v4 offset:61440
    v_mfma_f32_16x16x32_bf16 v[232:235], v[64:67], a[120:123], v[232:235]
    v_exp_f32 v131, v131
    v_mfma_f32_16x16x32_bf16 v[232:235], v[80:83], a[152:155], v[232:235]
    ds_read_b128 a[84:87], v5 offset:61440
    v_cvt_pk_bf16_f32 v129, v130, v131
    v_mfma_f32_16x16x32_bf16 a[248:251], v[40:43], a[124:127], a[248:251]
    v_exp_f32 v52, v52
    v_mfma_f32_16x16x32_bf16 a[248:251], v[56:59], a[156:159], a[248:251]
    s_waitcnt lgkmcnt(3)
    global_load_lds_dwordx4 v21, s[34:35] offset:1024 nt
    v_mfma_f32_16x16x32_bf16 v[244:247], v[64:67], a[124:127], v[244:247]
    v_exp_f32 v53, v53
    v_mfma_f32_16x16x32_bf16 v[244:247], v[80:83], a[156:159], v[244:247]
    ds_read_b128 a[88:91], v6 offset:61440
    v_cvt_pk_bf16_f32 v50, v52, v53
    v_mfma_f32_16x16x32_bf16 v[56:59], a[64:67], a[0:3], v[24:27]
    v_exp_f32 v54, v54
    v_mfma_f32_16x16x32_bf16 v[56:59], a[68:71], a[4:7], v[56:59]
    s_waitcnt lgkmcnt(3)
    s_add_u32 m0, s21, 114688
    ds_read_b128 a[92:95], v7 offset:61440
    v_mfma_f32_16x16x32_bf16 v[56:59], a[72:75], a[8:11], v[56:59]
    v_exp_f32 v55, v55
    v_mfma_f32_16x16x32_bf16 v[56:59], a[76:79], a[12:15], v[56:59]
    s_add_u32 s34, s34, 8192
    s_addc_u32 s35, s35, 0
    v_cvt_pk_bf16_f32 v51, v54, v55
    v_mfma_f32_16x16x32_bf16 v[80:83], a[64:67], a[16:19], v[28:31]
    v_exp_f32 v76, v76
    v_mfma_f32_16x16x32_bf16 v[80:83], a[68:71], a[20:23], v[80:83]
    global_load_lds_dwordx4 v16, s[32:33] nt
    v_mfma_f32_16x16x32_bf16 v[80:83], a[72:75], a[24:27], v[80:83]
    v_exp_f32 v77, v77
    v_mfma_f32_16x16x32_bf16 v[80:83], a[76:79], a[28:31], v[80:83]
    v_cvt_pk_bf16_f32 v74, v76, v77
    v_mfma_f32_16x16x32_bf16 v[96:99], a[64:67], a[32:35], v[32:35]
    v_exp_f32 v78, v78
    v_mfma_f32_16x16x32_bf16 v[96:99], a[68:71], a[36:39], v[96:99]
    v_mfma_f32_16x16x32_bf16 v[96:99], a[72:75], a[40:43], v[96:99]
    v_exp_f32 v79, v79
    v_mfma_f32_16x16x32_bf16 v[96:99], a[76:79], a[44:47], v[96:99]
    v_cvt_pk_bf16_f32 v75, v78, v79
    v_mfma_f32_16x16x32_bf16 v[120:123], a[64:67], a[48:51], v[36:39]
    v_exp_f32 v108, v108
    v_mfma_f32_16x16x32_bf16 v[120:123], a[68:71], a[52:55], v[120:123]
    s_waitcnt lgkmcnt(0)
    global_load_lds_dwordx4 v17, s[32:33] offset:1024 nt
    v_mfma_f32_16x16x32_bf16 v[120:123], a[72:75], a[56:59], v[120:123]
    v_exp_f32 v109, v109
    v_mfma_f32_16x16x32_bf16 v[120:123], a[76:79], a[60:63], v[120:123]
    v_cvt_pk_bf16_f32 v106, v108, v109
    v_mfma_f32_16x16x32_bf16 v[60:63], a[80:83], a[0:3], v[24:27]
    v_exp_f32 v110, v110
    v_mfma_f32_16x16x32_bf16 v[60:63], a[84:87], a[4:7], v[60:63]
    s_waitcnt vmcnt(10)
    s_barrier
    v_mfma_f32_16x16x32_bf16 v[60:63], a[88:91], a[8:11], v[60:63]
    v_exp_f32 v111, v111
    v_mfma_f32_16x16x32_bf16 v[60:63], a[92:95], a[12:15], v[60:63]
    ds_read_b64_tr_b16 a[96:97], v8 offset:16384
    v_cvt_pk_bf16_f32 v107, v110, v111
    v_mfma_f32_16x16x32_bf16 v[84:87], a[80:83], a[16:19], v[28:31]
    v_exp_f32 v132, v132
    v_mfma_f32_16x16x32_bf16 v[84:87], a[84:87], a[20:23], v[84:87]
    s_add_u32 s32, s32, 8192
    s_addc_u32 s33, s33, 0
    ds_read_b64_tr_b16 a[98:99], v8 offset:20480
    v_mfma_f32_16x16x32_bf16 v[84:87], a[88:91], a[24:27], v[84:87]
    v_exp_f32 v133, v133
    v_mfma_f32_16x16x32_bf16 v[84:87], a[92:95], a[28:31], v[84:87]
    ds_read_b64_tr_b16 a[100:101], v9 offset:16384
    v_cvt_pk_bf16_f32 v130, v132, v133
    v_mfma_f32_16x16x32_bf16 v[100:103], a[80:83], a[32:35], v[32:35]
    v_exp_f32 v134, v134
    v_mfma_f32_16x16x32_bf16 v[100:103], a[84:87], a[36:39], v[100:103]
    s_sub_u32 s24, s24, 1
    ds_read_b64_tr_b16 a[102:103], v9 offset:20480
    v_mfma_f32_16x16x32_bf16 v[100:103], a[88:91], a[40:43], v[100:103]
    v_exp_f32 v135, v135
    v_mfma_f32_16x16x32_bf16 v[100:103], a[92:95], a[44:47], v[100:103]
    ds_read_b64_tr_b16 a[104:105], v10 offset:16384
    v_cvt_pk_bf16_f32 v131, v134, v135
    v_mfma_f32_16x16x32_bf16 v[124:127], a[80:83], a[48:51], v[36:39]
    ds_read_b64_tr_b16 a[106:107], v10 offset:20480
    v_mfma_f32_16x16x32_bf16 v[124:127], a[84:87], a[52:55], v[124:127]
    ds_read_b64_tr_b16 a[108:109], v11 offset:16384
    v_mfma_f32_16x16x32_bf16 v[124:127], a[88:91], a[56:59], v[124:127]
    s_cmp_lg_u32 s24, 0
    ds_read_b64_tr_b16 a[110:111], v11 offset:20480
    v_mfma_f32_16x16x32_bf16 v[124:127], a[92:95], a[60:63], v[124:127]
    s_waitcnt lgkmcnt(6)
    s_cbranch_scc1 L_loop
L_exit:
    v_mfma_f32_16x16x32_bf16 v[144:147], v[88:91], a[128:131], v[144:147]
    v_exp_f32 v56, v56
    v_mfma_f32_16x16x32_bf16 v[144:147], v[104:107], a[96:99], v[144:147]
    s_waitcnt lgkmcnt(4)
    ds_read_b64_tr_b16 a[112:113], v12 offset:16384
    v_mfma_f32_16x16x32_bf16 v[148:151], v[112:115], a[128:131], v[148:151]
    v_exp_f32 v57, v57
    v_mfma_f32_16x16x32_bf16 v[148:151], v[128:131], a[96:99], v[148:151]
    ds_read_b64_tr_b16 a[114:115], v12 offset:20480
    v_cvt_pk_bf16_f32 v56, v56, v57
    v_mfma_f32_16x16x32_bf16 v[160:163], v[88:91], a[132:135], v[160:163]
    v_exp_f32 v58, v58
    v_mfma_f32_16x16x32_bf16 v[160:163], v[104:107], a[100:103], v[160:163]
    s_waitcnt lgkmcnt(4)
    ds_read_b64_tr_b16 a[116:117], v13 offset:16384
    v_mfma_f32_16x16x32_bf16 v[164:167], v[112:115], a[132:135], v[164:167]
    v_exp_f32 v59, v59
    v_mfma_f32_16x16x32_bf16 v[164:167], v[128:131], a[100:103], v[164:167]
    ds_read_b64_tr_b16 a[118:119], v13 offset:20480
    v_cvt_pk_bf16_f32 v57, v58, v59
    v_mfma_f32_16x16x32_bf16 v[176:179], v[88:91], a[136:139], v[176:179]
    v_exp_f32 v80, v80
    v_mfma_f32_16x16x32_bf16 v[176:179], v[104:107], a[104:107], v[176:179]
    ds_read_b64_tr_b16 a[120:121], v14 offset:16384
    v_mfma_f32_16x16x32_bf16 v[180:183], v[112:115], a[136:139], v[180:183]
    v_exp_f32 v81, v81
    v_mfma_f32_16x16x32_bf16 v[180:183], v[128:131], a[104:107], v[180:183]
    ds_read_b64_tr_b16 a[122:123], v14 offset:20480
    v_cvt_pk_bf16_f32 v80, v80, v81
    v_mfma_f32_16x16x32_bf16 a[232:235], v[88:91], a[240:243], a[232:235]
    v_exp_f32 v82, v82
    v_mfma_f32_16x16x32_bf16 a[232:235], v[104:107], a[240:243], a[232:235]
    s_waitcnt lgkmcnt(4)
    ds_read_b64_tr_b16 a[124:125], v15 offset:16384
    v_mfma_f32_16x16x32_bf16 v[192:195], v[88:91], a[140:143], v[192:195]
    v_exp_f32 v83, v83
    v_mfma_f32_16x16x32_bf16 v[192:195], v[104:107], a[108:111], v[192:195]
    ds_read_b64_tr_b16 a[126:127], v15 offset:20480
    v_cvt_pk_bf16_f32 v81, v82, v83
    v_mfma_f32_16x16x32_bf16 v[196:199], v[112:115], a[140:143], v[196:199]
    v_exp_f32 v96, v96
    v_mfma_f32_16x16x32_bf16 v[196:199], v[128:131], a[108:111], v[196:199]
    v_mfma_f32_16x16x32_bf16 v[208:211], v[88:91], a[144:147], v[208:211]
    v_exp_f32 v97, v97
    v_mfma_f32_16x16x32_bf16 v[208:211], v[104:107], a[112:115], v[208:211]
    ds_read_b128 a[64:67], v4 offset:32768
    v_cvt_pk_bf16_f32 v96, v96, v97
    v_mfma_f32_16x16x32_bf16 v[212:215], v[112:115], a[144:147], v[212:215]
    v_exp_f32 v98, v98
    v_mfma_f32_16x16x32_bf16 v[212:215], v[128:131], a[112:115], v[212:215]
    s_waitcnt lgkmcnt(3)
    ds_read_b128 a[68:71], v5 offset:32768
    v_mfma_f32_16x16x32_bf16 v[224:227], v[88:91], a[148:151], v[224:227]
    v_exp_f32 v99, v99
    v_mfma_f32_16x16x32_bf16 v[224:227], v[104:107], a[116:119], v[224:227]
    ds_read_b128 a[72:75], v6 offset:32768
    v_cvt_pk_bf16_f32 v97, v98, v99
    v_mfma_f32_16x16x32_bf16 v[228:231], v[112:115], a[148:151], v[228:231]
    v_exp_f32 v120, v120
    v_mfma_f32_16x16x32_bf16 v[228:231], v[128:131], a[116:119], v[228:231]
    v_mfma_f32_16x16x32_bf16 a[236:239], v[112:115], a[240:243], a[236:239]
    v_exp_f32 v121, v121
    v_mfma_f32_16x16x32_bf16 a[236:239], v[128:131], a[240:243], a[236:239]
    ds_read_b128 a[76:79], v7 offset:32768
    v_cvt_pk_bf16_f32 v120, v120, v121
    v_mfma_f32_16x16x32_bf16 v[236:239], v[88:91], a[152:155], v[236:239]
    v_exp_f32 v122, v122
    v_mfma_f32_16x16x32_bf16 v[236:239], v[104:107], a[120:123], v[236:239]
    s_waitcnt lgkmcnt(4)
    ds_read_b128 a[80:83], v4 offset:36864
    v_mfma_f32_16x16x32_bf16 v[240:243], v[112:115], a[152:155], v[240:243]
    v_exp_f32 v123, v123
    v_mfma_f32_16x16x32_bf16 v[240:243], v[128:131], a[120:123], v[240:243]
    ds_read_b128 a[84:87], v5 offset:36864
    v_cvt_pk_bf16_f32 v121, v122, v123
    v_mfma_f32_16x16x32_bf16 v[248:251], v[88:91], a[156:159], v[248:251]
    v_exp_f32 v60, v60
    v_mfma_f32_16x16x32_bf16 v[248:251], v[104:107], a[124:127], v[248:251]
    s_waitcnt lgkmcnt(3)
    v_mfma_f32_16x16x32_bf16 v[252:255], v[112:115], a[156:159], v[252:255]
    v_exp_f32 v61, v61
    v_mfma_f32_16x16x32_bf16 v[252:255], v[128:131], a[124:127], v[252:255]
    ds_read_b128 a[88:91], v6 offset:36864
    v_cvt_pk_bf16_f32 v58, v60, v61
    v_mfma_f32_16x16x32_bf16 v[40:43], a[64:67], a[0:3], v[24:27]
    v_exp_f32 v62, v62
    v_mfma_f32_16x16x32_bf16 v[40:43], a[68:71], a[4:7], v[40:43]
    s_waitcnt lgkmcnt(3)
    ds_read_b128 a[92:95], v7 offset:36864
    v_mfma_f32_16x16x32_bf16 v[40:43], a[72:75], a[8:11], v[40:43]
    v_exp_f32 v63, v63
    v_mfma_f32_16x16x32_bf16 v[40:43], a[76:79], a[12:15], v[40:43]
    v_cvt_pk_bf16_f32 v59, v62, v63
    v_mfma_f32_16x16x32_bf16 v[64:67], a[64:67], a[16:19], v[28:31]
    v_exp_f32 v84, v84
    v_mfma_f32_16x16x32_bf16 v[64:67], a[68:71], a[20:23], v[64:67]
    v_mfma_f32_16x16x32_bf16 v[64:67], a[72:75], a[24:27], v[64:67]
    v_exp_f32 v85, v85
    v_mfma_f32_16x16x32_bf16 v[64:67], a[76:79], a[28:31], v[64:67]
    v_cvt_pk_bf16_f32 v82, v84, v85
    v_mfma_f32_16x16x32_bf16 v[104:107], a[64:67], a[32:35], v[32:35]
    v_exp_f32 v86, v86
    v_mfma_f32_16x16x32_bf16 v[104:107], a[68:71], a[36:39], v[104:107]
    v_mfma_f32_16x16x32_bf16 v[104:107], a[72:75], a[40:43], v[104:107]
    v_exp_f32 v87, v87
    v_mfma_f32_16x16x32_bf16 v[104:107], a[76:79], a[44:47], v[104:107]
    v_cvt_pk_bf16_f32 v83, v86, v87
    v_mfma_f32_16x16x32_bf16 v[128:131], a[64:67], a[48:51], v[36:39]
    v_exp_f32 v100, v100
    v_mfma_f32_16x16x32_bf16 v[128:131], a[68:71], a[52:55], v[128:131]
    s_waitcnt lgkmcnt(0)
    v_mfma_f32_16x16x32_bf16 v[128:131], a[72:75], a[56:59], v[128:131]
    v_exp_f32 v101, v101
    v_mfma_f32_16x16x32_bf16 v[128:131], a[76:79], a[60:63], v[128:131]
    v_cvt_pk_bf16_f32 v98, v100, v101
    v_mfma_f32_16x16x32_bf16 v[44:47], a[80:83], a[0:3], v[24:27]
    v_exp_f32 v102, v102
    v_mfma_f32_16x16x32_bf16 v[44:47], a[84:87], a[4:7], v[44:47]
    s_waitcnt vmcnt(4)
    s_barrier
    v_mfma_f32_16x16x32_bf16 v[44:47], a[88:91], a[8:11], v[44:47]
    v_exp_f32 v103, v103
    v_mfma_f32_16x16x32_bf16 v[44:47], a[92:95], a[12:15], v[44:47]
    ds_read_b64_tr_b16 a[128:129], v8 offset:24576
    v_cvt_pk_bf16_f32 v99, v102, v103
    v_mfma_f32_16x16x32_bf16 v[68:71], a[80:83], a[16:19], v[28:31]
    v_exp_f32 v124, v124
    v_mfma_f32_16x16x32_bf16 v[68:71], a[84:87], a[20:23], v[68:71]
    ds_read_b64_tr_b16 a[130:131], v8 offset:28672
    v_mfma_f32_16x16x32_bf16 v[68:71], a[88:91], a[24:27], v[68:71]
    v_exp_f32 v125, v125
    v_mfma_f32_16x16x32_bf16 v[68:71], a[92:95], a[28:31], v[68:71]
    ds_read_b64_tr_b16 a[132:133], v9 offset:24576
    v_cvt_pk_bf16_f32 v122, v124, v125
    v_mfma_f32_16x16x32_bf16 v[108:111], a[80:83], a[32:35], v[32:35]
    v_exp_f32 v126, v126
    v_mfma_f32_16x16x32_bf16 v[108:111], a[84:87], a[36:39], v[108:111]
    ds_read_b64_tr_b16 a[134:135], v9 offset:28672
    v_mfma_f32_16x16x32_bf16 v[108:111], a[88:91], a[40:43], v[108:111]
    v_exp_f32 v127, v127
    v_mfma_f32_16x16x32_bf16 v[108:111], a[92:95], a[44:47], v[108:111]
    ds_read_b64_tr_b16 a[136:137], v10 offset:24576
    v_cvt_pk_bf16_f32 v123, v126, v127
    v_mfma_f32_16x16x32_bf16 v[132:135], a[80:83], a[48:51], v[36:39]
    ds_read_b64_tr_b16 a[138:139], v10 offset:28672
    v_mfma_f32_16x16x32_bf16 v[132:135], a[84:87], a[52:55], v[132:135]
    ds_read_b64_tr_b16 a[140:141], v11 offset:24576
    v_mfma_f32_16x16x32_bf16 v[132:135], a[88:91], a[56:59], v[132:135]
    ds_read_b64_tr_b16 a[142:143], v11 offset:28672
    v_mfma_f32_16x16x32_bf16 v[132:135], a[92:95], a[60:63], v[132:135]
    s_waitcnt lgkmcnt(6)
    v_mfma_f32_16x16x32_bf16 v[136:139], v[48:51], a[96:99], v[136:139]
    v_exp_f32 v40, v40
    v_mfma_f32_16x16x32_bf16 v[136:139], v[56:59], a[128:131], v[136:139]
    s_waitcnt lgkmcnt(4)
    ds_read_b64_tr_b16 a[144:145], v12 offset:24576
    v_mfma_f32_16x16x32_bf16 v[140:143], v[72:75], a[96:99], v[140:143]
    v_exp_f32 v41, v41
    v_mfma_f32_16x16x32_bf16 v[140:143], v[80:83], a[128:131], v[140:143]
    ds_read_b64_tr_b16 a[146:147], v12 offset:28672
    v_cvt_pk_bf16_f32 v40, v40, v41
    v_mfma_f32_16x16x32_bf16 v[152:155], v[48:51], a[100:103], v[152:155]
    v_exp_f32 v42, v42
    v_mfma_f32_16x16x32_bf16 v[152:155], v[56:59], a[132:135], v[152:155]
    s_waitcnt lgkmcnt(4)
    ds_read_b64_tr_b16 a[148:149], v13 offset:24576
    v_mfma_f32_16x16x32_bf16 v[156:159], v[72:75], a[100:103], v[156:159]
    v_exp_f32 v43, v43
    v_mfma_f32_16x16x32_bf16 v[156:159], v[80:83], a[132:135], v[156:159]
    ds_read_b64_tr_b16 a[150:151], v13 offset:28672
    v_cvt_pk_bf16_f32 v41, v42, v43
    v_mfma_f32_16x16x32_bf16 v[168:171], v[48:51], a[104:107], v[168:171]
    v_exp_f32 v64, v64
    v_mfma_f32_16x16x32_bf16 v[168:171], v[56:59], a[136:139], v[168:171]
    ds_read_b64_tr_b16 a[152:153], v14 offset:24576
    v_mfma_f32_16x16x32_bf16 v[172:175], v[72:75], a[104:107], v[172:175]
    v_exp_f32 v65, v65
    v_mfma_f32_16x16x32_bf16 v[172:175], v[80:83], a[136:139], v[172:175]
    ds_read_b64_tr_b16 a[154:155], v14 offset:28672
    v_cvt_pk_bf16_f32 v64, v64, v65
    v_mfma_f32_16x16x32_bf16 a[224:227], v[48:51], a[240:243], a[224:227]
    v_exp_f32 v66, v66
    v_mfma_f32_16x16x32_bf16 a[224:227], v[56:59], a[240:243], a[224:227]
    s_waitcnt lgkmcnt(4)
    ds_read_b64_tr_b16 a[156:157], v15 offset:24576
    v_mfma_f32_16x16x32_bf16 v[184:187], v[48:51], a[108:111], v[184:187]
    v_exp_f32 v67, v67
    v_mfma_f32_16x16x32_bf16 v[184:187], v[56:59], a[140:143], v[184:187]
    ds_read_b64_tr_b16 a[158:159], v15 offset:28672
    v_cvt_pk_bf16_f32 v65, v66, v67
    v_mfma_f32_16x16x32_bf16 v[188:191], v[72:75], a[108:111], v[188:191]
    v_exp_f32 v104, v104
    v_mfma_f32_16x16x32_bf16 v[188:191], v[80:83], a[140:143], v[188:191]
    v_mfma_f32_16x16x32_bf16 v[200:203], v[48:51], a[112:115], v[200:203]
    v_exp_f32 v105, v105
    v_mfma_f32_16x16x32_bf16 v[200:203], v[56:59], a[144:147], v[200:203]
    ds_read_b128 a[64:67], v4 offset:40960
    v_cvt_pk_bf16_f32 v104, v104, v105
    v_mfma_f32_16x16x32_bf16 v[204:207], v[72:75], a[112:115], v[204:207]
    v_exp_f32 v106, v106
    v_mfma_f32_16x16x32_bf16 v[204:207], v[80:83], a[144:147], v[204:207]
    s_waitcnt lgkmcnt(3)
    ds_read_b128 a[68:71], v5 offset:40960
    v_mfma_f32_16x16x32_bf16 v[216:219], v[48:51], a[116:119], v[216:219]
    v_exp_f32 v107, v107
    v_mfma_f32_16x16x32_bf16 v[216:219], v[56:59], a[148:151], v[216:219]
    ds_read_b128 a[72:75], v6 offset:40960
    v_cvt_pk_bf16_f32 v105, v106, v107
    v_mfma_f32_16x16x32_bf16 v[220:223], v[72:75], a[116:119], v[220:223]
    v_exp_f32 v128, v128
    v_mfma_f32_16x16x32_bf16 v[220:223], v[80:83], a[148:151], v[220:223]
    v_mfma_f32_16x16x32_bf16 a[228:231], v[72:75], a[240:243], a[228:231]
    v_exp_f32 v129, v129
    v_mfma_f32_16x16x32_bf16 a[228:231], v[80:83], a[240:243], a[228:231]
    ds_read_b128 a[76:79], v7 offset:40960
    v_cvt_pk_bf16_f32 v128, v128, v129
    v_mfma_f32_16x16x32_bf16 a[244:247], v[48:51], a[120:123], a[244:247]
    v_exp_f32 v130, v130
    v_mfma_f32_16x16x32_bf16 a[244:247], v[56:59], a[152:155], a[244:247]
    s_waitcnt lgkmcnt(4)
    ds_read_b128 a[80:83], v4 offset:45056
    v_mfma_f32_16x16x32_bf16 v[232:235], v[72:75], a[120:123], v[232:235]
    v_exp_f32 v131, v131
    v_mfma_f32_16x16x32_bf16 v[232:235], v[80:83], a[152:155], v[232:235]
    ds_read_b128 a[84:87], v5 offset:45056
    v_cvt_pk_bf16_f32 v129, v130, v131
    v_mfma_f32_16x16x32_bf16 a[248:251], v[48:51], a[124:127], a[248:251]
    v_exp_f32 v44, v44
    v_mfma_f32_16x16x32_bf16 a[248:251], v[56:59], a[156:159], a[248:251]
    s_waitcnt lgkmcnt(3)
    v_mfma_f32_16x16x32_bf16 v[244:247], v[72:75], a[124:127], v[244:247]
    v_exp_f32 v45, v45
    v_mfma_f32_16x16x32_bf16 v[244:247], v[80:83], a[156:159], v[244:247]
    ds_read_b128 a[88:91], v6 offset:45056
    v_cvt_pk_bf16_f32 v42, v44, v45
    v_mfma_f32_16x16x32_bf16 v[56:59], a[64:67], a[0:3], v[24:27]
    v_exp_f32 v46, v46
    v_mfma_f32_16x16x32_bf16 v[56:59], a[68:71], a[4:7], v[56:59]
    s_waitcnt lgkmcnt(3)
    ds_read_b128 a[92:95], v7 offset:45056
    v_mfma_f32_16x16x32_bf16 v[56:59], a[72:75], a[8:11], v[56:59]
    v_exp_f32 v47, v47
    v_mfma_f32_16x16x32_bf16 v[56:59], a[76:79], a[12:15], v[56:59]
    v_cvt_pk_bf16_f32 v43, v46, v47
    v_mfma_f32_16x16x32_bf16 v[80:83], a[64:67], a[16:19], v[28:31]
    v_exp_f32 v68, v68
    v_mfma_f32_16x16x32_bf16 v[80:83], a[68:71], a[20:23], v[80:83]
    v_mfma_f32_16x16x32_bf16 v[80:83], a[72:75], a[24:27], v[80:83]
    v_exp_f32 v69, v69
    v_mfma_f32_16x16x32_bf16 v[80:83], a[76:79], a[28:31], v[80:83]
    v_cvt_pk_bf16_f32 v66, v68, v69
    v_mfma_f32_16x16x32_bf16 v[88:91], a[64:67], a[32:35], v[32:35]
    v_exp_f32 v70, v70
    v_mfma_f32_16x16x32_bf16 v[88:91], a[68:71], a[36:39], v[88:91]
    v_mfma_f32_16x16x32_bf16 v[88:91], a[72:75], a[40:43], v[88:91]
    v_exp_f32 v71, v71
    v_mfma_f32_16x16x32_bf16 v[88:91], a[76:79], a[44:47], v[88:91]
    v_cvt_pk_bf16_f32 v67, v70, v71
    v_mfma_f32_16x16x32_bf16 v[112:115], a[64:67], a[48:51], v[36:39]
    v_exp_f32 v108, v108
    v_mfma_f32_16x16x32_bf16 v[112:115], a[68:71], a[52:55], v[112:115]
    s_waitcnt lgkmcnt(0)
    v_mfma_f32_16x16x32_bf16 v[112:115], a[72:75], a[56:59], v[112:115]
    v_exp_f32 v109, v109
    v_mfma_f32_16x16x32_bf16 v[112:115], a[76:79], a[60:63], v[112:115]
    v_cvt_pk_bf16_f32 v106, v108, v109
    v_mfma_f32_16x16x32_bf16 v[60:63], a[80:83], a[0:3], v[24:27]
    v_exp_f32 v110, v110
    v_mfma_f32_16x16x32_bf16 v[60:63], a[84:87], a[4:7], v[60:63]
    s_waitcnt vmcnt(0)
    s_barrier
    v_mfma_f32_16x16x32_bf16 v[60:63], a[88:91], a[8:11], v[60:63]
    v_exp_f32 v111, v111
    v_mfma_f32_16x16x32_bf16 v[60:63], a[92:95], a[12:15], v[60:63]
    ds_read_b64_tr_b16 a[96:97], v8 offset:0
    v_cvt_pk_bf16_f32 v107, v110, v111
    v_mfma_f32_16x16x32_bf16 v[84:87], a[80:83], a[16:19], v[28:31]
    v_exp_f32 v132, v132
    v_mfma_f32_16x16x32_bf16 v[84:87], a[84:87], a[20:23], v[84:87]
    ds_read_b64_tr_b16 a[98:99], v8 offset:4096
    v_mfma_f32_16x16x32_bf16 v[84:87], a[88:91], a[24:27], v[84:87]
    v_exp_f32 v133, v133
    v_mfma_f32_16x16x32_bf16 v[84:87], a[92:95], a[28:31], v[84:87]
    ds_read_b64_tr_b16 a[100:101], v9 offset:0
    v_cvt_pk_bf16_f32 v130, v132, v133
    v_mfma_f32_16x16x32_bf16 v[92:95], a[80:83], a[32:35], v[32:35]
    v_exp_f32 v134, v134
    v_mfma_f32_16x16x32_bf16 v[92:95], a[84:87], a[36:39], v[92:95]
    ds_read_b64_tr_b16 a[102:103], v9 offset:4096
    v_mfma_f32_16x16x32_bf16 v[92:95], a[88:91], a[40:43], v[92:95]
    v_exp_f32 v135, v135
    v_mfma_f32_16x16x32_bf16 v[92:95], a[92:95], a[44:47], v[92:95]
    ds_read_b64_tr_b16 a[104:105], v10 offset:0
    v_cvt_pk_bf16_f32 v131, v134, v135
    v_mfma_f32_16x16x32_bf16 v[116:119], a[80:83], a[48:51], v[36:39]
    ds_read_b64_tr_b16 a[106:107], v10 offset:4096
    v_mfma_f32_16x16x32_bf16 v[116:119], a[84:87], a[52:55], v[116:119]
    ds_read_b64_tr_b16 a[108:109], v11 offset:0
    v_mfma_f32_16x16x32_bf16 v[116:119], a[88:91], a[56:59], v[116:119]
    ds_read_b64_tr_b16 a[110:111], v11 offset:4096
    v_mfma_f32_16x16x32_bf16 v[116:119], a[92:95], a[60:63], v[116:119]
    s_waitcnt lgkmcnt(6)
    v_mfma_f32_16x16x32_bf16 a[232:235], v[96:99], a[240:243], a[232:235]
    s_waitcnt lgkmcnt(0)
    ds_read_b128 a[64:67], v4 offset:49152
    v_and_b32 v16, 48, v0
    v_mfma_f32_16x16x32_bf16 a[232:235], v[104:107], a[240:243], a[232:235]
    ds_read_b128 a[80:83], v4 offset:53248
    v_lshlrev_b32 v16, 6, v16
    v_mfma_f32_16x16x32_bf16 v[144:147], v[96:99], a[128:131], v[144:147]
    ds_read_b128 a[68:71], v5 offset:49152
    v_and_b32 v22, 15, v0
    v_mfma_f32_16x16x32_bf16 v[144:147], v[104:107], a[96:99], v[144:147]
    ds_read_b128 a[84:87], v5 offset:53248
    v_lshl_or_b32 v22, v22, 4, v16
    v_mfma_f32_16x16x32_bf16 v[160:163], v[96:99], a[132:135], v[160:163]
    ds_read_b128 a[72:75], v6 offset:49152
    v_and_b32 v17, 16, v0
    v_mfma_f32_16x16x32_bf16 v[160:163], v[104:107], a[100:103], v[160:163]
    ds_read_b128 a[88:91], v6 offset:53248
    v_lshl_or_b32 v16, v17, 1, v16
    v_mfma_f32_16x16x32_bf16 v[176:179], v[96:99], a[136:139], v[176:179]
    ds_read_b128 a[76:79], v7 offset:49152
    v_and_b32 v17, 3, v0
    v_mfma_f32_16x16x32_bf16 v[176:179], v[104:107], a[104:107], v[176:179]
    ds_read_b128 a[92:95], v7 offset:53248
    v_lshl_or_b32 v16, v17, 6, v16
    v_mfma_f32_16x16x32_bf16 v[192:195], v[96:99], a[140:143], v[192:195]
    ds_read_b64_tr_b16 a[112:113], v12 offset:0
    v_and_b32 v17, 12, v0
    v_mfma_f32_16x16x32_bf16 v[192:195], v[104:107], a[108:111], v[192:195]
    s_waitcnt lgkmcnt(8)
    ds_read_b64_tr_b16 a[114:115], v12 offset:4096
    v_lshl_or_b32 v16, v17, 1, v16
    v_mfma_f32_16x16x32_bf16 v[208:211], v[96:99], a[144:147], v[208:211]
    s_waitcnt lgkmcnt(8)
    ds_read_b64_tr_b16 a[116:117], v13 offset:0
    v_add_u32 v16, s56, v16
    v_mfma_f32_16x16x32_bf16 v[224:227], v[96:99], a[148:151], v[224:227]
    s_waitcnt lgkmcnt(8)
    ds_read_b64_tr_b16 a[118:119], v13 offset:4096
    v_xor_b32 v17, 32, v16
    v_mfma_f32_16x16x32_bf16 v[236:239], v[96:99], a[152:155], v[236:239]
    s_waitcnt lgkmcnt(8)
    ds_read_b64_tr_b16 a[120:121], v14 offset:0
    v_exp_f32 v88, v88
    v_mfma_f32_16x16x32_bf16 v[248:251], v[96:99], a[156:159], v[248:251]
    s_waitcnt lgkmcnt(7)
    ds_read_b64_tr_b16 a[122:123], v14 offset:4096
    v_exp_f32 v89, v89
    v_mfma_f32_16x16x32_bf16 v[108:111], a[80:83], a[32:35], v[32:35]
    s_waitcnt lgkmcnt(7)
    ds_read_b64_tr_b16 a[124:125], v15 offset:0
    v_cvt_pk_bf16_f32 v88, v88, v89
    v_mfma_f32_16x16x32_bf16 v[108:111], a[84:87], a[36:39], v[108:111]
    s_waitcnt lgkmcnt(7)
    ds_read_b64_tr_b16 a[126:127], v15 offset:4096
    v_exp_f32 v90, v90
    v_mfma_f32_16x16x32_bf16 v[108:111], a[88:91], a[40:43], v[108:111]
    s_waitcnt lgkmcnt(7)
    ds_read_b128 a[160:163], v4 offset:24576
    v_exp_f32 v91, v91
    v_mfma_f32_16x16x32_bf16 v[108:111], a[92:95], a[44:47], v[108:111]
    s_waitcnt lgkmcnt(7)
    ds_read_b128 a[176:179], v4 offset:28672
    v_cvt_pk_bf16_f32 v89, v90, v91
    v_mfma_f32_16x16x32_bf16 v[208:211], v[104:107], a[112:115], v[208:211]
    s_waitcnt lgkmcnt(7)
    ds_read_b128 a[164:167], v5 offset:24576
    v_exp_f32 v92, v92
    s_waitcnt lgkmcnt(7)
    v_mfma_f32_16x16x32_bf16 v[224:227], v[104:107], a[116:119], v[224:227]
    s_waitcnt lgkmcnt(6)
    ds_read_b128 a[180:183], v5 offset:28672
    v_exp_f32 v93, v93
    v_mfma_f32_16x16x32_bf16 a[236:239], v[120:123], a[240:243], a[236:239]
    s_waitcnt lgkmcnt(6)
    ds_read_b128 a[168:171], v6 offset:24576
    v_cvt_pk_bf16_f32 v90, v92, v93
    v_mfma_f32_16x16x32_bf16 v[236:239], v[104:107], a[120:123], v[236:239]
    s_waitcnt lgkmcnt(6)
    ds_read_b128 a[184:187], v6 offset:28672
    v_exp_f32 v94, v94
    v_mfma_f32_16x16x32_bf16 a[236:239], v[128:131], a[240:243], a[236:239]
    s_waitcnt lgkmcnt(6)
    ds_read_b128 a[172:175], v7 offset:24576
    v_exp_f32 v95, v95
    v_mfma_f32_16x16x32_bf16 v[248:251], v[104:107], a[124:127], v[248:251]
    s_waitcnt lgkmcnt(6)
    ds_read_b128 a[188:191], v7 offset:28672
    v_cvt_pk_bf16_f32 v91, v94, v95
    v_mfma_f32_16x16x32_bf16 v[104:107], a[64:67], a[32:35], v[32:35]
    s_waitcnt lgkmcnt(6)
    ds_read_b64_tr_b16 a[192:193], v8 offset:40960
    v_exp_f32 v108, v108
    v_mfma_f32_16x16x32_bf16 v[104:107], a[68:71], a[36:39], v[104:107]
    s_waitcnt lgkmcnt(6)
    ds_read_b64_tr_b16 a[194:195], v8 offset:45056
    v_exp_f32 v109, v109
    v_mfma_f32_16x16x32_bf16 v[104:107], a[72:75], a[40:43], v[104:107]
    s_waitcnt lgkmcnt(6)
    ds_read_b64_tr_b16 a[196:197], v9 offset:40960
    v_exp_f32 v110, v110
    v_mfma_f32_16x16x32_bf16 v[104:107], a[76:79], a[44:47], v[104:107]
    s_waitcnt lgkmcnt(6)
    ds_read_b64_tr_b16 a[198:199], v9 offset:45056
    v_exp_f32 v111, v111
    v_mfma_f32_16x16x32_bf16 v[96:99], a[160:163], a[32:35], v[32:35]
    s_waitcnt lgkmcnt(6)
    ds_read_b64_tr_b16 a[200:201], v10 offset:40960
    v_exp_f32 v112, v112
    v_mfma_f32_16x16x32_bf16 v[96:99], a[164:167], a[36:39], v[96:99]
    s_waitcnt lgkmcnt(6)
    ds_read_b64_tr_b16 a[202:203], v10 offset:45056
    v_exp_f32 v104, v104
    v_mfma_f32_16x16x32_bf16 v[96:99], a[168:171], a[40:43], v[96:99]
    s_waitcnt lgkmcnt(6)
    ds_read_b64_tr_b16 a[204:205], v11 offset:40960
    v_exp_f32 v105, v105
    v_mfma_f32_16x16x32_bf16 v[96:99], a[172:175], a[44:47], v[96:99]
    s_waitcnt lgkmcnt(6)
    ds_read_b64_tr_b16 a[206:207], v11 offset:45056
    v_cvt_pk_bf16_f32 v104, v104, v105
    v_mfma_f32_16x16x32_bf16 v[100:103], a[176:179], a[32:35], v[32:35]
    s_waitcnt lgkmcnt(6)
    ds_read_b64_tr_b16 a[208:209], v12 offset:40960
    v_exp_f32 v106, v106
    v_mfma_f32_16x16x32_bf16 v[100:103], a[180:183], a[36:39], v[100:103]
    s_waitcnt lgkmcnt(6)
    ds_read_b64_tr_b16 a[210:211], v12 offset:45056
    v_exp_f32 v107, v107
    v_mfma_f32_16x16x32_bf16 v[100:103], a[184:187], a[40:43], v[100:103]
    s_waitcnt lgkmcnt(6)
    ds_read_b64_tr_b16 a[212:213], v13 offset:40960
    v_cvt_pk_bf16_f32 v105, v106, v107
    v_mfma_f32_16x16x32_bf16 v[100:103], a[188:191], a[44:47], v[100:103]
    s_waitcnt lgkmcnt(6)
    ds_read_b64_tr_b16 a[214:215], v13 offset:45056
    v_cvt_pk_bf16_f32 v106, v108, v109
    v_mfma_f32_16x16x32_bf16 a[232:235], v[88:91], a[240:243], a[232:235]
    ds_read_b64_tr_b16 a[216:217], v14 offset:40960
    v_cvt_pk_bf16_f32 v107, v110, v111
    v_mfma_f32_16x16x32_bf16 v[144:147], v[88:91], a[192:195], v[144:147]
    s_waitcnt lgkmcnt(7)
    ds_read_b64_tr_b16 a[218:219], v14 offset:45056
    v_exp_f32 v96, v96
    v_mfma_f32_16x16x32_bf16 v[160:163], v[88:91], a[196:199], v[160:163]
    s_waitcnt lgkmcnt(7)
    ds_read_b64_tr_b16 a[220:221], v15 offset:40960
    v_exp_f32 v97, v97
    v_mfma_f32_16x16x32_bf16 v[176:179], v[88:91], a[200:203], v[176:179]
    s_waitcnt lgkmcnt(7)
    ds_read_b64_tr_b16 a[222:223], v15 offset:45056
    v_cvt_pk_bf16_f32 v96, v96, v97
    v_mfma_f32_16x16x32_bf16 v[192:195], v[88:91], a[204:207], v[192:195]
    s_waitcnt lgkmcnt(7)
    v_exp_f32 v98, v98
    v_mfma_f32_16x16x32_bf16 v[148:151], v[120:123], a[128:131], v[148:151]
    s_waitcnt lgkmcnt(6)
    ds_read_b64_tr_b16 a[128:129], v8 offset:49152
    v_exp_f32 v99, v99
    v_mfma_f32_16x16x32_bf16 v[208:211], v[88:91], a[208:211], v[208:211]
    s_waitcnt lgkmcnt(6)
    ds_read_b64_tr_b16 a[130:131], v8 offset:53248
    v_cvt_pk_bf16_f32 v97, v98, v99
    v_mfma_f32_16x16x32_bf16 v[148:151], v[128:131], a[96:99], v[148:151]
    s_waitcnt lgkmcnt(6)
    v_exp_f32 v100, v100
    v_mfma_f32_16x16x32_bf16 v[224:227], v[88:91], a[212:215], v[224:227]
    s_waitcnt lgkmcnt(5)
    v_exp_f32 v101, v101
    v_mfma_f32_16x16x32_bf16 v[164:167], v[120:123], a[132:135], v[164:167]
    s_waitcnt lgkmcnt(4)
    ds_read_b64_tr_b16 a[132:133], v9 offset:49152
    v_cvt_pk_bf16_f32 v98, v100, v101
    v_mfma_f32_16x16x32_bf16 v[236:239], v[88:91], a[216:219], v[236:239]
    s_waitcnt lgkmcnt(4)
    ds_read_b64_tr_b16 a[134:135], v9 offset:53248
    v_exp_f32 v102, v102
    v_mfma_f32_16x16x32_bf16 v[164:167], v[128:131], a[100:103], v[164:167]
    s_waitcnt lgkmcnt(4)
    v_exp_f32 v103, v103
    v_mfma_f32_16x16x32_bf16 v[248:251], v[88:91], a[220:223], v[248:251]
    v_cvt_pk_bf16_f32 v99, v102, v103
    v_exp_f32 v113, v113
    v_mfma_f32_16x16x32_bf16 v[180:183], v[120:123], a[136:139], v[180:183]
    s_waitcnt lgkmcnt(3)
    ds_read_b64_tr_b16 a[136:137], v10 offset:49152
    v_cvt_pk_bf16_f32 v112, v112, v113
    v_mfma_f32_16x16x32_bf16 v[180:183], v[128:131], a[104:107], v[180:183]
    s_waitcnt lgkmcnt(3)
    ds_read_b64_tr_b16 a[138:139], v10 offset:53248
    v_exp_f32 v114, v114
    v_mfma_f32_16x16x32_bf16 v[196:199], v[120:123], a[140:143], v[196:199]
    ds_read_b64_tr_b16 a[140:141], v11 offset:49152
    v_exp_f32 v115, v115
    v_mfma_f32_16x16x32_bf16 v[196:199], v[128:131], a[108:111], v[196:199]
    ds_read_b64_tr_b16 a[142:143], v11 offset:53248
    v_cvt_pk_bf16_f32 v113, v114, v115
    v_mfma_f32_16x16x32_bf16 v[212:215], v[120:123], a[144:147], v[212:215]
    s_waitcnt lgkmcnt(5)
    ds_read_b64_tr_b16 a[144:145], v12 offset:49152
    v_exp_f32 v116, v116
    v_mfma_f32_16x16x32_bf16 v[212:215], v[128:131], a[112:115], v[212:215]
    s_waitcnt lgkmcnt(5)
    ds_read_b64_tr_b16 a[146:147], v12 offset:53248
    v_exp_f32 v117, v117
    v_mfma_f32_16x16x32_bf16 v[228:231], v[120:123], a[148:151], v[228:231]
    ds_read_b64_tr_b16 a[148:149], v13 offset:49152
    v_cvt_pk_bf16_f32 v114, v116, v117
    v_mfma_f32_16x16x32_bf16 v[228:231], v[128:131], a[116:119], v[228:231]
    ds_read_b64_tr_b16 a[150:151], v13 offset:53248
    v_exp_f32 v118, v118
    v_mfma_f32_16x16x32_bf16 v[240:243], v[120:123], a[152:155], v[240:243]
    s_waitcnt lgkmcnt(6)
    ds_read_b64_tr_b16 a[152:153], v14 offset:49152
    v_exp_f32 v119, v119
    v_mfma_f32_16x16x32_bf16 v[240:243], v[128:131], a[120:123], v[240:243]
    s_waitcnt lgkmcnt(6)
    ds_read_b64_tr_b16 a[154:155], v14 offset:53248
    v_cvt_pk_bf16_f32 v115, v118, v119
    v_mfma_f32_16x16x32_bf16 v[252:255], v[120:123], a[156:159], v[252:255]
    ds_read_b64_tr_b16 a[156:157], v15 offset:49152
    v_exp_f32 v56, v56
    v_mfma_f32_16x16x32_bf16 v[252:255], v[128:131], a[124:127], v[252:255]
    s_waitcnt lgkmcnt(6)
    ds_read_b64_tr_b16 a[158:159], v15 offset:53248
    v_exp_f32 v57, v57
    v_mfma_f32_16x16x32_bf16 v[128:131], a[64:67], a[48:51], v[36:39]
    s_waitcnt lgkmcnt(6)
    v_cvt_pk_bf16_f32 v56, v56, v57
    v_exp_f32 v58, v58
    v_mfma_f32_16x16x32_bf16 v[128:131], a[68:71], a[52:55], v[128:131]
    s_waitcnt lgkmcnt(5)
    v_exp_f32 v59, v59
    v_mfma_f32_16x16x32_bf16 v[128:131], a[72:75], a[56:59], v[128:131]
    s_waitcnt lgkmcnt(4)
    v_cvt_pk_bf16_f32 v57, v58, v59
    v_exp_f32 v60, v60
    v_mfma_f32_16x16x32_bf16 v[128:131], a[76:79], a[60:63], v[128:131]
    s_waitcnt lgkmcnt(3)
    v_exp_f32 v61, v61
    v_mfma_f32_16x16x32_bf16 v[132:135], a[80:83], a[48:51], v[36:39]
    v_cvt_pk_bf16_f32 v58, v60, v61
    v_exp_f32 v62, v62
    v_mfma_f32_16x16x32_bf16 v[132:135], a[84:87], a[52:55], v[132:135]
    s_waitcnt lgkmcnt(1)
    v_exp_f32 v63, v63
    v_mfma_f32_16x16x32_bf16 v[132:135], a[88:91], a[56:59], v[132:135]
    v_exp_f32 v128, v128
    v_mfma_f32_16x16x32_bf16 v[132:135], a[92:95], a[60:63], v[132:135]
    s_waitcnt lgkmcnt(0)
    v_exp_f32 v129, v129
    v_mfma_f32_16x16x32_bf16 v[48:51], a[64:67], a[0:3], v[24:27]
    v_cvt_pk_bf16_f32 v128, v128, v129
    v_cvt_pk_bf16_f32 v59, v62, v63
    v_mfma_f32_16x16x32_bf16 v[48:51], a[68:71], a[4:7], v[48:51]
    v_exp_f32 v130, v130
    v_mfma_f32_16x16x32_bf16 v[48:51], a[72:75], a[8:11], v[48:51]
    v_exp_f32 v131, v131
    v_mfma_f32_16x16x32_bf16 v[48:51], a[76:79], a[12:15], v[48:51]
    v_cvt_pk_bf16_f32 v129, v130, v131
    v_exp_f32 v132, v132
    v_mfma_f32_16x16x32_bf16 v[52:55], a[80:83], a[0:3], v[24:27]
    v_exp_f32 v133, v133
    v_mfma_f32_16x16x32_bf16 v[52:55], a[84:87], a[4:7], v[52:55]
    v_cvt_pk_bf16_f32 v130, v132, v133
    v_exp_f32 v134, v134
    v_mfma_f32_16x16x32_bf16 v[52:55], a[88:91], a[8:11], v[52:55]
    v_exp_f32 v135, v135
    v_mfma_f32_16x16x32_bf16 v[52:55], a[92:95], a[12:15], v[52:55]
    v_cvt_pk_bf16_f32 v131, v134, v135
    v_exp_f32 v48, v48
    v_mfma_f32_16x16x32_bf16 v[72:75], a[64:67], a[16:19], v[28:31]
    ds_read_b64_tr_b16 a[64:65], v8 offset:57344
    v_exp_f32 v49, v49
    v_mfma_f32_16x16x32_bf16 v[72:75], a[68:71], a[20:23], v[72:75]
    ds_read_b64_tr_b16 a[66:67], v8 offset:61440
    v_cvt_pk_bf16_f32 v48, v48, v49
    v_mfma_f32_16x16x32_bf16 v[72:75], a[72:75], a[24:27], v[72:75]
    ds_read_b64_tr_b16 a[68:69], v9 offset:57344
    v_exp_f32 v50, v50
    v_mfma_f32_16x16x32_bf16 v[72:75], a[76:79], a[28:31], v[72:75]
    ds_read_b64_tr_b16 a[70:71], v9 offset:61440
    v_exp_f32 v51, v51
    v_mfma_f32_16x16x32_bf16 v[76:79], a[80:83], a[16:19], v[28:31]
    ds_read_b64_tr_b16 a[72:73], v10 offset:57344
    v_cvt_pk_bf16_f32 v49, v50, v51
    v_mfma_f32_16x16x32_bf16 v[76:79], a[84:87], a[20:23], v[76:79]
    ds_read_b64_tr_b16 a[74:75], v10 offset:61440
    v_exp_f32 v52, v52
    v_mfma_f32_16x16x32_bf16 v[76:79], a[88:91], a[24:27], v[76:79]
    ds_read_b64_tr_b16 a[76:77], v11 offset:57344
    v_exp_f32 v53, v53
    v_mfma_f32_16x16x32_bf16 v[76:79], a[92:95], a[28:31], v[76:79]
    s_waitcnt lgkmcnt(6)
    ds_read_b64_tr_b16 a[78:79], v11 offset:61440
    v_cvt_pk_bf16_f32 v50, v52, v53
    v_mfma_f32_16x16x32_bf16 a[232:235], v[104:107], a[240:243], a[232:235]
    ds_read_b64_tr_b16 a[80:81], v12 offset:57344
    v_exp_f32 v54, v54
    v_mfma_f32_16x16x32_bf16 a[232:235], v[96:99], a[240:243], a[232:235]
    s_waitcnt lgkmcnt(6)
    ds_read_b64_tr_b16 a[82:83], v12 offset:61440
    v_exp_f32 v55, v55
    v_mfma_f32_16x16x32_bf16 v[144:147], v[104:107], a[128:131], v[144:147]
    s_waitcnt lgkmcnt(6)
    ds_read_b64_tr_b16 a[84:85], v13 offset:57344
    v_cvt_pk_bf16_f32 v51, v54, v55
    v_mfma_f32_16x16x32_bf16 v[144:147], v[96:99], a[64:67], v[144:147]
    ds_read_b64_tr_b16 a[86:87], v13 offset:61440
    v_accvgpr_read_b32 v32, a232
    v_mfma_f32_16x16x32_bf16 v[160:163], v[104:107], a[132:135], v[160:163]
    s_waitcnt lgkmcnt(7)
    ds_read_b64_tr_b16 a[88:89], v14 offset:57344
    v_accvgpr_read_b32 v33, a233
    v_mfma_f32_16x16x32_bf16 v[160:163], v[96:99], a[68:71], v[160:163]
    s_waitcnt lgkmcnt(7)
    ds_read_b64_tr_b16 a[90:91], v14 offset:61440
    v_accvgpr_read_b32 v34, a234
    v_mfma_f32_16x16x32_bf16 v[176:179], v[104:107], a[136:139], v[176:179]
    s_waitcnt lgkmcnt(7)
    ds_read_b64_tr_b16 a[92:93], v15 offset:57344
    v_accvgpr_read_b32 v35, a235
    v_mfma_f32_16x16x32_bf16 v[176:179], v[96:99], a[72:75], v[176:179]
    s_waitcnt lgkmcnt(7)
    ds_read_b64_tr_b16 a[94:95], v15 offset:61440
    v_max3_f32 v18, v32, v33, v34
    v_mfma_f32_16x16x32_bf16 v[192:195], v[104:107], a[140:143], v[192:195]
    s_waitcnt lgkmcnt(7)
    v_max_f32 v18, v35, v18
    v_rcp_f32 v32, v32
    v_mfma_f32_16x16x32_bf16 v[192:195], v[96:99], a[76:79], v[192:195]
    s_waitcnt lgkmcnt(6)
    v_rcp_f32 v33, v33
    v_mfma_f32_16x16x32_bf16 v[208:211], v[104:107], a[144:147], v[208:211]
    s_waitcnt lgkmcnt(5)
    v_rcp_f32 v34, v34
    v_mfma_f32_16x16x32_bf16 v[208:211], v[96:99], a[80:83], v[208:211]
    s_waitcnt lgkmcnt(4)
    v_rcp_f32 v35, v35
    v_mfma_f32_16x16x32_bf16 v[224:227], v[104:107], a[148:151], v[224:227]
    s_waitcnt lgkmcnt(3)
    v_mul_f32 v144, v32, v144
    v_mul_f32 v160, v32, v160
    v_mfma_f32_16x16x32_bf16 v[224:227], v[96:99], a[84:87], v[224:227]
    s_waitcnt lgkmcnt(2)
    v_mul_f32 v176, v32, v176
    v_mul_f32 v192, v32, v192
    v_mfma_f32_16x16x32_bf16 v[236:239], v[104:107], a[152:155], v[236:239]
    s_waitcnt lgkmcnt(1)
    v_mul_f32 v208, v32, v208
    v_cvt_pk_bf16_f32 v88, v144, v160
    v_mfma_f32_16x16x32_bf16 v[236:239], v[96:99], a[88:91], v[236:239]
    s_waitcnt lgkmcnt(0)
    v_mul_f32 v224, v32, v224
    v_cvt_pk_bf16_f32 v89, v176, v192
    v_mfma_f32_16x16x32_bf16 v[248:251], v[104:107], a[156:159], v[248:251]
    ds_write_b64 v19, v[88:89] offset:0
    v_mfma_f32_16x16x32_bf16 v[248:251], v[96:99], a[92:95], v[248:251]
    v_cvt_pk_bf16_f32 v90, v208, v224
    v_mul_f32 v145, v33, v145
    v_mul_f32 v236, v32, v236
    v_mul_f32 v161, v33, v161
    v_mul_f32 v177, v33, v177
    v_mul_f32 v193, v33, v193
    v_mul_f32 v209, v33, v209
    v_mul_f32 v225, v33, v225
    v_mul_f32 v248, v32, v248
    v_cvt_pk_bf16_f32 v91, v236, v248
    v_mfma_f32_16x16x32_bf16 v[120:123], a[160:163], a[48:51], v[36:39]
    ds_write_b64 v19, v[90:91] offset:128
    v_mfma_f32_16x16x32_bf16 v[120:123], a[164:167], a[52:55], v[120:123]
    ds_read_b64_tr_b16 v[88:89], v16 offset:0
    v_mul_f32 v237, v33, v237
    v_mfma_f32_16x16x32_bf16 v[120:123], a[168:171], a[56:59], v[120:123]
    ds_read_b64_tr_b16 v[90:91], v17 offset:0
    v_mul_f32 v249, v33, v249
    v_cvt_pk_bf16_f32 v92, v145, v161
    v_cvt_pk_bf16_f32 v93, v177, v193
    v_mfma_f32_16x16x32_bf16 v[120:123], a[172:175], a[60:63], v[120:123]
    ds_write_b64 v19, v[92:93] offset:256
    v_cvt_pk_bf16_f32 v94, v209, v225
    v_cvt_pk_bf16_f32 v95, v237, v249
    v_mul_f32 v146, v34, v146
    v_mul_f32 v162, v34, v162
    v_mul_f32 v178, v34, v178
    v_mul_f32 v194, v34, v194
    v_mfma_f32_16x16x32_bf16 v[124:127], a[176:179], a[48:51], v[36:39]
    ds_write_b64 v19, v[94:95] offset:384
    v_mfma_f32_16x16x32_bf16 v[124:127], a[180:183], a[52:55], v[124:127]
    ds_read_b64_tr_b16 v[92:93], v16 offset:256
    v_mul_f32 v210, v34, v210
    v_mfma_f32_16x16x32_bf16 v[124:127], a[184:187], a[56:59], v[124:127]
    ds_read_b64_tr_b16 v[94:95], v17 offset:256
    v_mul_f32 v226, v34, v226
    v_mul_f32 v238, v34, v238
    v_mul_f32 v250, v34, v250
    v_cvt_pk_bf16_f32 v96, v146, v162
    v_cvt_pk_bf16_f32 v97, v178, v194
    v_mfma_f32_16x16x32_bf16 v[124:127], a[188:191], a[60:63], v[124:127]
    s_waitcnt lgkmcnt(5)
    ds_write_b64 v19, v[96:97] offset:512
    v_cvt_pk_bf16_f32 v98, v210, v226
    v_mfma_f32_16x16x32_bf16 a[236:239], v[112:115], a[240:243], a[236:239]
    s_waitcnt lgkmcnt(5)
    buffer_store_dwordx4 v[88:91], v22, s[16:19], s54 offen nt
    v_cvt_pk_bf16_f32 v99, v238, v250
    v_mul_f32 v147, v35, v147
    v_mfma_f32_16x16x32_bf16 v[148:151], v[112:115], a[192:195], v[148:151]
    ds_write_b64 v19, v[98:99] offset:640
    v_mfma_f32_16x16x32_bf16 v[164:167], v[112:115], a[196:199], v[164:167]
    ds_read_b64_tr_b16 v[96:97], v16 offset:512
    v_mul_f32 v163, v35, v163
    v_mfma_f32_16x16x32_bf16 v[180:183], v[112:115], a[200:203], v[180:183]
    ds_read_b64_tr_b16 v[98:99], v17 offset:512
    v_mul_f32 v179, v35, v179
    v_mul_f32 v195, v35, v195
    v_mul_f32 v211, v35, v211
    v_mul_f32 v227, v35, v227
    v_mul_f32 v239, v35, v239
    v_mul_f32 v251, v35, v251
    v_cvt_pk_bf16_f32 v100, v147, v163
    v_cvt_pk_bf16_f32 v101, v179, v195
    v_mfma_f32_16x16x32_bf16 v[196:199], v[112:115], a[204:207], v[196:199]
    s_waitcnt lgkmcnt(4)
    buffer_store_dwordx4 v[92:95], v22, s[16:19], s54 offen offset:256 nt
    v_cvt_pk_bf16_f32 v102, v211, v227
    v_mfma_f32_16x16x32_bf16 v[212:215], v[112:115], a[208:211], v[212:215]
    ds_write_b64 v19, v[100:101] offset:768
    v_cvt_pk_bf16_f32 v103, v239, v251
    v_mfma_f32_16x16x32_bf16 v[228:231], v[112:115], a[212:215], v[228:231]
    v_exp_f32 v120, v120
    v_mfma_f32_16x16x32_bf16 v[240:243], v[112:115], a[216:219], v[240:243]
    ds_write_b64 v19, v[102:103] offset:896
    v_mfma_f32_16x16x32_bf16 v[252:255], v[112:115], a[220:223], v[252:255]
    ds_read_b64_tr_b16 v[100:101], v16 offset:768
    v_exp_f32 v121, v121
    v_mfma_f32_16x16x32_bf16 a[236:239], v[128:131], a[240:243], a[236:239]
    s_waitcnt lgkmcnt(3)
    ds_read_b64_tr_b16 v[102:103], v17 offset:768
    v_cvt_pk_bf16_f32 v120, v120, v121
    v_mfma_f32_16x16x32_bf16 v[148:151], v[128:131], a[128:131], v[148:151]
    buffer_store_dwordx4 v[96:99], v22, s[16:19], s54 offen offset:512 nt
    v_exp_f32 v122, v122
    v_exp_f32 v123, v123
    v_exp_f32 v124, v124
    v_cvt_pk_bf16_f32 v121, v122, v123
    v_exp_f32 v125, v125
    v_exp_f32 v126, v126
    v_cvt_pk_bf16_f32 v122, v124, v125
    v_exp_f32 v127, v127
    v_mfma_f32_16x16x32_bf16 v[164:167], v[128:131], a[132:135], v[164:167]
    v_cvt_pk_bf16_f32 v123, v126, v127
    v_exp_f32 v80, v80
    v_mfma_f32_16x16x32_bf16 v[180:183], v[128:131], a[136:139], v[180:183]
    v_exp_f32 v81, v81
    v_mfma_f32_16x16x32_bf16 a[236:239], v[120:123], a[240:243], a[236:239]
    s_waitcnt lgkmcnt(1)
    v_cvt_pk_bf16_f32 v80, v80, v81
    v_exp_f32 v82, v82
    v_mfma_f32_16x16x32_bf16 v[148:151], v[120:123], a[64:67], v[148:151]
    s_waitcnt lgkmcnt(0)
    buffer_store_dwordx4 v[100:103], v22, s[16:19], s54 offen offset:768 nt
    v_exp_f32 v83, v83
    v_mfma_f32_16x16x32_bf16 v[164:167], v[120:123], a[68:71], v[164:167]
    v_accvgpr_read_b32 v36, a236
    v_accvgpr_read_b32 v37, a237
    v_mfma_f32_16x16x32_bf16 v[180:183], v[120:123], a[72:75], v[180:183]
    v_accvgpr_read_b32 v38, a238
    v_accvgpr_read_b32 v39, a239
    v_mfma_f32_16x16x32_bf16 v[196:199], v[128:131], a[140:143], v[196:199]
    v_max3_f32 v18, v36, v37, v18
    v_max3_f32 v18, v38, v39, v18
    v_mfma_f32_16x16x32_bf16 v[196:199], v[120:123], a[76:79], v[196:199]
    v_rcp_f32 v36, v36
    v_mfma_f32_16x16x32_bf16 v[212:215], v[128:131], a[144:147], v[212:215]
    v_rcp_f32 v37, v37
    v_mfma_f32_16x16x32_bf16 v[212:215], v[120:123], a[80:83], v[212:215]
    v_rcp_f32 v38, v38
    v_mfma_f32_16x16x32_bf16 v[228:231], v[128:131], a[148:151], v[228:231]
    v_rcp_f32 v39, v39
    v_mfma_f32_16x16x32_bf16 v[228:231], v[120:123], a[84:87], v[228:231]
    v_mul_f32 v148, v36, v148
    v_mul_f32 v164, v36, v164
    v_mfma_f32_16x16x32_bf16 v[240:243], v[128:131], a[152:155], v[240:243]
    v_mul_f32 v180, v36, v180
    v_mul_f32 v196, v36, v196
    v_mfma_f32_16x16x32_bf16 v[240:243], v[120:123], a[88:91], v[240:243]
    v_mul_f32 v212, v36, v212
    v_cvt_pk_bf16_f32 v112, v148, v164
    v_mfma_f32_16x16x32_bf16 v[252:255], v[128:131], a[156:159], v[252:255]
    v_mul_f32 v228, v36, v228
    v_cvt_pk_bf16_f32 v113, v180, v196
    v_mfma_f32_16x16x32_bf16 v[252:255], v[120:123], a[92:95], v[252:255]
    ds_write_b64 v19, v[112:113] offset:4096
    v_cvt_pk_bf16_f32 v114, v212, v228
    v_mul_f32 v240, v36, v240
    v_mul_f32 v149, v37, v149
    v_mul_f32 v165, v37, v165
    v_mul_f32 v181, v37, v181
    v_mul_f32 v197, v37, v197
    v_mul_f32 v213, v37, v213
    v_mul_f32 v252, v36, v252
    v_cvt_pk_bf16_f32 v115, v240, v252
    v_mfma_f32_16x16x32_bf16 a[224:227], v[40:43], a[240:243], a[224:227]
    ds_write_b64 v19, v[114:115] offset:4224
    v_mfma_f32_16x16x32_bf16 a[224:227], v[56:59], a[240:243], a[224:227]
    ds_read_b64_tr_b16 v[112:113], v16 offset:4096
    v_mul_f32 v229, v37, v229
    v_mfma_f32_16x16x32_bf16 v[136:139], v[40:43], a[96:99], v[136:139]
    ds_read_b64_tr_b16 v[114:115], v17 offset:4096
    v_mul_f32 v241, v37, v241
    v_mul_f32 v253, v37, v253
    v_cvt_pk_bf16_f32 v116, v149, v165
    v_cvt_pk_bf16_f32 v117, v181, v197
    v_mfma_f32_16x16x32_bf16 v[136:139], v[56:59], a[192:195], v[136:139]
    ds_write_b64 v19, v[116:117] offset:4352
    v_cvt_pk_bf16_f32 v118, v213, v229
    v_cvt_pk_bf16_f32 v119, v241, v253
    v_mul_f32 v150, v38, v150
    v_mul_f32 v166, v38, v166
    v_mul_f32 v182, v38, v182
    v_mul_f32 v198, v38, v198
    v_mfma_f32_16x16x32_bf16 v[152:155], v[40:43], a[100:103], v[152:155]
    ds_write_b64 v19, v[118:119] offset:4480
    v_mfma_f32_16x16x32_bf16 v[152:155], v[56:59], a[196:199], v[152:155]
    ds_read_b64_tr_b16 v[116:117], v16 offset:4352
    v_mul_f32 v214, v38, v214
    v_mfma_f32_16x16x32_bf16 v[168:171], v[40:43], a[104:107], v[168:171]
    ds_read_b64_tr_b16 v[118:119], v17 offset:4352
    v_mul_f32 v230, v38, v230
    v_mul_f32 v242, v38, v242
    v_mul_f32 v254, v38, v254
    v_cvt_pk_bf16_f32 v120, v150, v166
    v_cvt_pk_bf16_f32 v121, v182, v198
    v_mfma_f32_16x16x32_bf16 v[168:171], v[56:59], a[200:203], v[168:171]
    s_waitcnt lgkmcnt(4)
    ds_write_b64 v19, v[120:121] offset:4608
    v_mfma_f32_16x16x32_bf16 v[184:187], v[40:43], a[108:111], v[184:187]
    buffer_store_dwordx4 v[112:115], v22, s[16:19], s55 offen nt
    v_cvt_pk_bf16_f32 v122, v214, v230
    v_cvt_pk_bf16_f32 v123, v242, v254
    v_mul_f32 v151, v39, v151
    v_mfma_f32_16x16x32_bf16 v[184:187], v[56:59], a[204:207], v[184:187]
    ds_write_b64 v19, v[122:123] offset:4736
    v_mfma_f32_16x16x32_bf16 v[200:203], v[40:43], a[112:115], v[200:203]
    ds_read_b64_tr_b16 v[120:121], v16 offset:4608
    v_mul_f32 v167, v39, v167
    v_mfma_f32_16x16x32_bf16 v[200:203], v[56:59], a[208:211], v[200:203]
    ds_read_b64_tr_b16 v[122:123], v17 offset:4608
    v_mul_f32 v183, v39, v183
    v_mul_f32 v199, v39, v199
    v_mul_f32 v215, v39, v215
    v_mul_f32 v231, v39, v231
    v_mul_f32 v243, v39, v243
    v_mul_f32 v255, v39, v255
    v_cvt_pk_bf16_f32 v124, v151, v167
    v_cvt_pk_bf16_f32 v125, v183, v199
    v_mfma_f32_16x16x32_bf16 v[216:219], v[40:43], a[116:119], v[216:219]
    s_waitcnt lgkmcnt(4)
    buffer_store_dwordx4 v[116:119], v22, s[16:19], s55 offen offset:256 nt
    v_cvt_pk_bf16_f32 v126, v215, v231
    v_mfma_f32_16x16x32_bf16 v[216:219], v[56:59], a[212:215], v[216:219]
    ds_write_b64 v19, v[124:125] offset:4864
    v_cvt_pk_bf16_f32 v127, v243, v255
    v_mfma_f32_16x16x32_bf16 a[244:247], v[40:43], a[120:123], a[244:247]
    v_cvt_pk_bf16_f32 v81, v82, v83
    v_exp_f32 v84, v84
    v_mfma_f32_16x16x32_bf16 a[244:247], v[56:59], a[216:219], a[244:247]
    ds_write_b64 v19, v[126:127] offset:4992
    v_mfma_f32_16x16x32_bf16 a[248:251], v[40:43], a[124:127], a[248:251]
    s_waitcnt lgkmcnt(3)
    ds_read_b64_tr_b16 v[124:125], v16 offset:4864
    v_exp_f32 v85, v85
    v_mfma_f32_16x16x32_bf16 a[248:251], v[56:59], a[220:223], a[248:251]
    s_waitcnt lgkmcnt(3)
    ds_read_b64_tr_b16 v[126:127], v17 offset:4864
    v_cvt_pk_bf16_f32 v82, v84, v85
    v_mfma_f32_16x16x32_bf16 v[56:59], a[160:163], a[0:3], v[24:27]
    buffer_store_dwordx4 v[120:123], v22, s[16:19], s55 offen offset:512 nt
    v_exp_f32 v86, v86
    v_mfma_f32_16x16x32_bf16 v[56:59], a[164:167], a[4:7], v[56:59]
    v_exp_f32 v87, v87
    v_mfma_f32_16x16x32_bf16 v[56:59], a[168:171], a[8:11], v[56:59]
    v_cvt_pk_bf16_f32 v83, v86, v87
    v_exp_f32 v72, v72
    v_mfma_f32_16x16x32_bf16 v[56:59], a[172:175], a[12:15], v[56:59]
    v_exp_f32 v73, v73
    v_mfma_f32_16x16x32_bf16 v[60:63], a[176:179], a[0:3], v[24:27]
    v_cvt_pk_bf16_f32 v72, v72, v73
    v_exp_f32 v74, v74
    v_mfma_f32_16x16x32_bf16 v[60:63], a[180:183], a[4:7], v[60:63]
    v_exp_f32 v75, v75
    v_mfma_f32_16x16x32_bf16 v[60:63], a[184:187], a[8:11], v[60:63]
    s_waitcnt lgkmcnt(1)
    v_exp_f32 v56, v56
    v_mfma_f32_16x16x32_bf16 v[60:63], a[188:191], a[12:15], v[60:63]
    s_waitcnt lgkmcnt(0)
    buffer_store_dwordx4 v[124:127], v22, s[16:19], s55 offen offset:768 nt
    v_exp_f32 v57, v57
    v_exp_f32 v58, v58
    v_cvt_pk_bf16_f32 v56, v56, v57
    v_exp_f32 v59, v59
    v_mfma_f32_16x16x32_bf16 a[224:227], v[48:51], a[240:243], a[224:227]
    v_cvt_pk_bf16_f32 v57, v58, v59
    v_exp_f32 v60, v60
    v_exp_f32 v61, v61
    v_exp_f32 v62, v62
    v_cvt_pk_bf16_f32 v58, v60, v61
    v_exp_f32 v63, v63
    v_mfma_f32_16x16x32_bf16 v[136:139], v[48:51], a[128:131], v[136:139]
    v_cvt_pk_bf16_f32 v59, v62, v63
    v_cvt_pk_bf16_f32 v73, v74, v75
    v_mfma_f32_16x16x32_bf16 v[152:155], v[48:51], a[132:135], v[152:155]
    v_exp_f32 v76, v76
    v_mfma_f32_16x16x32_bf16 a[224:227], v[56:59], a[240:243], a[224:227]
    v_exp_f32 v77, v77
    v_mfma_f32_16x16x32_bf16 v[136:139], v[56:59], a[64:67], v[136:139]
    v_cvt_pk_bf16_f32 v74, v76, v77
    v_exp_f32 v78, v78
    v_mfma_f32_16x16x32_bf16 v[152:155], v[56:59], a[68:71], v[152:155]
    v_exp_f32 v79, v79
    v_mfma_f32_16x16x32_bf16 v[168:171], v[48:51], a[136:139], v[168:171]
    v_cvt_pk_bf16_f32 v75, v78, v79
    v_accvgpr_read_b32 v24, a224
    v_mfma_f32_16x16x32_bf16 v[168:171], v[56:59], a[72:75], v[168:171]
    v_accvgpr_read_b32 v25, a225
    v_accvgpr_read_b32 v26, a226
    v_mfma_f32_16x16x32_bf16 v[184:187], v[48:51], a[140:143], v[184:187]
    v_accvgpr_read_b32 v27, a227
    v_max3_f32 v18, v24, v25, v18
    v_mfma_f32_16x16x32_bf16 v[184:187], v[56:59], a[76:79], v[184:187]
    v_max3_f32 v18, v26, v27, v18
    v_rcp_f32 v24, v24
    v_mfma_f32_16x16x32_bf16 v[200:203], v[48:51], a[144:147], v[200:203]
    v_rcp_f32 v25, v25
    v_mfma_f32_16x16x32_bf16 v[200:203], v[56:59], a[80:83], v[200:203]
    v_rcp_f32 v26, v26
    v_mfma_f32_16x16x32_bf16 v[216:219], v[48:51], a[148:151], v[216:219]
    v_rcp_f32 v27, v27
    v_mfma_f32_16x16x32_bf16 v[216:219], v[56:59], a[84:87], v[216:219]
    v_mul_f32 v136, v24, v136
    v_mul_f32 v152, v24, v152
    v_mfma_f32_16x16x32_bf16 a[244:247], v[48:51], a[152:155], a[244:247]
    v_mul_f32 v168, v24, v168
    v_mul_f32 v184, v24, v184
    v_mfma_f32_16x16x32_bf16 a[244:247], v[56:59], a[88:91], a[244:247]
    v_mul_f32 v200, v24, v200
    v_cvt_pk_bf16_f32 v40, v136, v152
    v_mfma_f32_16x16x32_bf16 a[248:251], v[48:51], a[156:159], a[248:251]
    v_mul_f32 v216, v24, v216
    v_cvt_pk_bf16_f32 v41, v168, v184
    v_mfma_f32_16x16x32_bf16 a[248:251], v[56:59], a[92:95], a[248:251]
    ds_write_b64 v19, v[40:41] offset:0
    v_cvt_pk_bf16_f32 v42, v200, v216
    v_accvgpr_read_b32 v56, a244
    v_accvgpr_read_b32 v57, a245
    v_accvgpr_read_b32 v58, a246
    v_accvgpr_read_b32 v59, a247
    v_mul_f32 v56, v24, v56
    v_mul_f32 v137, v25, v137
    v_accvgpr_read_b32 v60, a248
    v_accvgpr_read_b32 v61, a249
    v_accvgpr_read_b32 v62, a250
    v_accvgpr_read_b32 v63, a251
    v_mul_f32 v60, v24, v60
    v_cvt_pk_bf16_f32 v43, v56, v60
    v_mfma_f32_16x16x32_bf16 a[228:231], v[64:67], a[240:243], a[228:231]
    ds_write_b64 v19, v[42:43] offset:128
    v_mfma_f32_16x16x32_bf16 a[228:231], v[80:83], a[240:243], a[228:231]
    ds_read_b64_tr_b16 v[40:41], v16 offset:0
    v_mul_f32 v153, v25, v153
    v_mfma_f32_16x16x32_bf16 v[140:143], v[64:67], a[96:99], v[140:143]
    ds_read_b64_tr_b16 v[42:43], v17 offset:0
    v_mul_f32 v169, v25, v169
    v_mul_f32 v185, v25, v185
    v_mul_f32 v201, v25, v201
    v_mul_f32 v217, v25, v217
    v_mul_f32 v57, v25, v57
    v_mul_f32 v61, v25, v61
    v_cvt_pk_bf16_f32 v44, v137, v153
    v_cvt_pk_bf16_f32 v45, v169, v185
    v_mfma_f32_16x16x32_bf16 v[140:143], v[80:83], a[192:195], v[140:143]
    ds_write_b64 v19, v[44:45] offset:256
    v_cvt_pk_bf16_f32 v46, v201, v217
    v_cvt_pk_bf16_f32 v47, v57, v61
    v_mul_f32 v138, v26, v138
    v_mul_f32 v154, v26, v154
    v_mul_f32 v170, v26, v170
    v_mul_f32 v186, v26, v186
    v_mfma_f32_16x16x32_bf16 v[156:159], v[64:67], a[100:103], v[156:159]
    ds_write_b64 v19, v[46:47] offset:384
    v_mfma_f32_16x16x32_bf16 v[156:159], v[80:83], a[196:199], v[156:159]
    ds_read_b64_tr_b16 v[44:45], v16 offset:256
    v_mul_f32 v202, v26, v202
    v_mfma_f32_16x16x32_bf16 v[172:175], v[64:67], a[104:107], v[172:175]
    s_waitcnt lgkmcnt(4)
    ds_read_b64_tr_b16 v[46:47], v17 offset:256
    v_mul_f32 v218, v26, v218
    v_mul_f32 v58, v26, v58
    v_mul_f32 v62, v26, v62
    v_cvt_pk_bf16_f32 v48, v138, v154
    v_cvt_pk_bf16_f32 v49, v170, v186
    v_mfma_f32_16x16x32_bf16 v[172:175], v[80:83], a[200:203], v[172:175]
    s_waitcnt lgkmcnt(4)
    buffer_store_dwordx4 v[40:43], v22, s[16:19], s52 offen nt
    v_cvt_pk_bf16_f32 v50, v202, v218
    v_mfma_f32_16x16x32_bf16 v[188:191], v[64:67], a[108:111], v[188:191]
    ds_write_b64 v19, v[48:49] offset:512
    v_cvt_pk_bf16_f32 v51, v58, v62
    v_mul_f32 v139, v27, v139
    v_mul_f32 v155, v27, v155
    v_mul_f32 v171, v27, v171
    v_mul_f32 v187, v27, v187
    v_mul_f32 v203, v27, v203
    v_mfma_f32_16x16x32_bf16 v[188:191], v[80:83], a[204:207], v[188:191]
    ds_write_b64 v19, v[50:51] offset:640
    v_mfma_f32_16x16x32_bf16 v[204:207], v[64:67], a[112:115], v[204:207]
    ds_read_b64_tr_b16 v[48:49], v16 offset:512
    v_mul_f32 v219, v27, v219
    v_mfma_f32_16x16x32_bf16 v[204:207], v[80:83], a[208:211], v[204:207]
    s_waitcnt lgkmcnt(4)
    ds_read_b64_tr_b16 v[50:51], v17 offset:512
    v_mul_f32 v59, v27, v59
    v_mul_f32 v63, v27, v63
    v_cvt_pk_bf16_f32 v52, v139, v155
    v_cvt_pk_bf16_f32 v53, v171, v187
    v_mfma_f32_16x16x32_bf16 v[220:223], v[64:67], a[116:119], v[220:223]
    s_waitcnt lgkmcnt(4)
    buffer_store_dwordx4 v[44:47], v22, s[16:19], s52 offen offset:256 nt
    v_cvt_pk_bf16_f32 v54, v203, v219
    v_mfma_f32_16x16x32_bf16 v[220:223], v[80:83], a[212:215], v[220:223]
    ds_write_b64 v19, v[52:53] offset:768
    v_cvt_pk_bf16_f32 v55, v59, v63
    v_mfma_f32_16x16x32_bf16 v[232:235], v[64:67], a[120:123], v[232:235]
    v_mfma_f32_16x16x32_bf16 v[232:235], v[80:83], a[216:219], v[232:235]
    ds_write_b64 v19, v[54:55] offset:896
    v_mfma_f32_16x16x32_bf16 v[244:247], v[64:67], a[124:127], v[244:247]
    ds_read_b64_tr_b16 v[52:53], v16 offset:768
    v_mfma_f32_16x16x32_bf16 v[244:247], v[80:83], a[220:223], v[244:247]
    ds_read_b64_tr_b16 v[54:55], v17 offset:768
    v_mfma_f32_16x16x32_bf16 v[80:83], a[160:163], a[16:19], v[28:31]
    s_waitcnt lgkmcnt(5)
    v_mfma_f32_16x16x32_bf16 v[80:83], a[164:167], a[20:23], v[80:83]
    s_waitcnt lgkmcnt(4)
    buffer_store_dwordx4 v[48:51], v22, s[16:19], s52 offen offset:512 nt
    v_mfma_f32_16x16x32_bf16 v[80:83], a[168:171], a[24:27], v[80:83]
    v_mfma_f32_16x16x32_bf16 v[80:83], a[172:175], a[28:31], v[80:83]
    s_nop 1
    v_mfma_f32_16x16x32_bf16 v[84:87], a[176:179], a[16:19], v[28:31]
    s_nop 1
    v_mfma_f32_16x16x32_bf16 v[84:87], a[180:183], a[20:23], v[84:87]
    s_nop 1
    v_mfma_f32_16x16x32_bf16 v[84:87], a[184:187], a[24:27], v[84:87]
    v_exp_f32 v80, v80
    v_mfma_f32_16x16x32_bf16 v[84:87], a[188:191], a[28:31], v[84:87]
    s_waitcnt lgkmcnt(1)
    v_exp_f32 v81, v81
    v_exp_f32 v82, v82
    v_mfma_f32_16x16x32_bf16 a[228:231], v[72:75], a[240:243], a[228:231]
    s_waitcnt lgkmcnt(0)
    buffer_store_dwordx4 v[52:55], v22, s[16:19], s52 offen offset:768 nt
    v_cvt_pk_bf16_f32 v80, v80, v81
    v_exp_f32 v83, v83
    v_exp_f32 v84, v84
    v_cvt_pk_bf16_f32 v81, v82, v83
    v_exp_f32 v85, v85
    v_exp_f32 v86, v86
    v_cvt_pk_bf16_f32 v82, v84, v85
    v_exp_f32 v87, v87
    v_mfma_f32_16x16x32_bf16 v[140:143], v[72:75], a[128:131], v[140:143]
    v_cvt_pk_bf16_f32 v83, v86, v87
    v_mfma_f32_16x16x32_bf16 v[156:159], v[72:75], a[132:135], v[156:159]
    v_mfma_f32_16x16x32_bf16 v[172:175], v[72:75], a[136:139], v[172:175]
    v_mfma_f32_16x16x32_bf16 a[228:231], v[80:83], a[240:243], a[228:231]
    s_nop 1
    v_mfma_f32_16x16x32_bf16 v[140:143], v[80:83], a[64:67], v[140:143]
    s_nop 1
    v_mfma_f32_16x16x32_bf16 v[156:159], v[80:83], a[68:71], v[156:159]
    s_nop 1
    v_mfma_f32_16x16x32_bf16 v[172:175], v[80:83], a[72:75], v[172:175]
    v_accvgpr_read_b32 v28, a228
    v_accvgpr_read_b32 v29, a229
    v_mfma_f32_16x16x32_bf16 v[188:191], v[72:75], a[140:143], v[188:191]
    v_accvgpr_read_b32 v30, a230
    v_accvgpr_read_b32 v31, a231
    v_mfma_f32_16x16x32_bf16 v[188:191], v[80:83], a[76:79], v[188:191]
    v_max3_f32 v18, v28, v29, v18
    v_max3_f32 v18, v30, v31, v18
    v_mfma_f32_16x16x32_bf16 v[204:207], v[72:75], a[144:147], v[204:207]
    v_rcp_f32 v28, v28
    v_mfma_f32_16x16x32_bf16 v[204:207], v[80:83], a[80:83], v[204:207]
    v_rcp_f32 v29, v29
    v_mfma_f32_16x16x32_bf16 v[220:223], v[72:75], a[148:151], v[220:223]
    v_rcp_f32 v30, v30
    v_mfma_f32_16x16x32_bf16 v[220:223], v[80:83], a[84:87], v[220:223]
    v_rcp_f32 v31, v31
    v_mfma_f32_16x16x32_bf16 v[232:235], v[72:75], a[152:155], v[232:235]
    v_mul_f32 v140, v28, v140
    v_mul_f32 v156, v28, v156
    v_mfma_f32_16x16x32_bf16 v[232:235], v[80:83], a[88:91], v[232:235]
    v_mul_f32 v172, v28, v172
    v_mul_f32 v188, v28, v188
    v_mfma_f32_16x16x32_bf16 v[244:247], v[72:75], a[156:159], v[244:247]
    v_mul_f32 v204, v28, v204
    v_mul_f32 v220, v28, v220
    v_mfma_f32_16x16x32_bf16 v[244:247], v[80:83], a[92:95], v[244:247]
    v_cvt_pk_bf16_f32 v64, v140, v156
    v_cvt_pk_bf16_f32 v65, v172, v188
    ds_write_b64 v19, v[64:65] offset:4096
    v_mul_f32 v232, v28, v232
    v_cvt_pk_bf16_f32 v66, v204, v220
    v_mul_f32 v141, v29, v141
    v_mul_f32 v157, v29, v157
    v_mul_f32 v173, v29, v173
    v_mul_f32 v244, v28, v244
    v_cvt_pk_bf16_f32 v67, v232, v244
    ds_write_b64 v19, v[66:67] offset:4224
    ds_read_b64_tr_b16 v[64:65], v16 offset:4096
    ds_read_b64_tr_b16 v[66:67], v17 offset:4096
    v_mul_f32 v189, v29, v189
    v_mul_f32 v205, v29, v205
    v_mul_f32 v221, v29, v221
    v_mul_f32 v233, v29, v233
    v_mul_f32 v245, v29, v245
    v_cvt_pk_bf16_f32 v68, v141, v157
    v_cvt_pk_bf16_f32 v69, v173, v189
    ds_write_b64 v19, v[68:69] offset:4352
    v_cvt_pk_bf16_f32 v70, v205, v221
    v_cvt_pk_bf16_f32 v71, v233, v245
    v_pk_mul_f32 v[142:143], v[142:143], v[30:31]
    v_pk_mul_f32 v[158:159], v[158:159], v[30:31]
    ds_write_b64 v19, v[70:71] offset:4480
    ds_read_b64_tr_b16 v[68:69], v16 offset:4352
    ds_read_b64_tr_b16 v[70:71], v17 offset:4352
    v_pk_mul_f32 v[174:175], v[174:175], v[30:31]
    v_pk_mul_f32 v[190:191], v[190:191], v[30:31]
    v_pk_mul_f32 v[206:207], v[206:207], v[30:31]
    v_pk_mul_f32 v[222:223], v[222:223], v[30:31]
    v_pk_mul_f32 v[234:235], v[234:235], v[30:31]
    v_pk_mul_f32 v[246:247], v[246:247], v[30:31]
    v_cvt_pk_bf16_f32 v72, v142, v158
    s_waitcnt lgkmcnt(4)
    buffer_store_dwordx4 v[64:67], v22, s[16:19], s53 offen nt
    v_cvt_pk_bf16_f32 v73, v174, v190
    ds_write_b64 v19, v[72:73] offset:4608
    v_cvt_pk_bf16_f32 v74, v206, v222
    v_cvt_pk_bf16_f32 v75, v234, v246
    v_cvt_pk_bf16_f32 v76, v143, v159
    v_cvt_pk_bf16_f32 v77, v175, v191
    ds_write_b64 v19, v[74:75] offset:4736
    ds_read_b64_tr_b16 v[72:73], v16 offset:4608
    ds_read_b64_tr_b16 v[74:75], v17 offset:4608
    ds_write_b64 v19, v[76:77] offset:4864
    s_waitcnt lgkmcnt(5)
    buffer_store_dwordx4 v[68:71], v22, s[16:19], s53 offen offset:256 nt
    v_cvt_pk_bf16_f32 v78, v207, v223
    v_cvt_pk_bf16_f32 v79, v235, v247
    ds_write_b64 v19, v[78:79] offset:4992
    ds_read_b64_tr_b16 v[76:77], v16 offset:4864
    ds_read_b64_tr_b16 v[78:79], v17 offset:4864
    s_waitcnt lgkmcnt(4)
    buffer_store_dwordx4 v[72:75], v22, s[16:19], s53 offen offset:512 nt
    s_waitcnt lgkmcnt(0)
    buffer_store_dwordx4 v[76:79], v22, s[16:19], s53 offen offset:768 nt
    v_cmp_le_f32 vcc, s29, v18
    s_nop 4
    s_cbranch_vccnz L_slow
L_end:
    s_endpgm
L_slow:
    s_waitcnt vmcnt(0) lgkmcnt(0)
    v_lshrrev_b32 v2, 4, v0
    v_and_b32 v3, 15, v0
    v_lshlrev_b32 v49, 8, v2
    v_lshlrev_b32 v48, 1, v2
    v_xor_b32 v48, v48, v3
    v_lshl_add_u32 v16, v48, 4, v49
    v_xor_b32 v17, 0x80, v16
    v_xor_b32 v48, v2, v3
    v_lshl_add_u32 v20, v48, 4, v49
    v_xor_b32 v21, 0x80, v20
    v_and_b32 v48, 7, v3
    v_lshlrev_b32 v48, 1, v48
    v_xor_b32 v48, v48, v2
    v_lshlrev_b32 v48, 4, v48
    v_lshl_add_u32 v52, v3, 8, v48
    v_lshrrev_b32 v48, 2, v3
    v_lshl_add_u32 v49, v2, 2, v48
    v_lshlrev_b32 v49, 8, v49
    v_and_b32 v50, 2, v3
    v_lshl_or_b32 v48, v50, 1, v48
    v_and_b32 v50, 1, v2
    v_lshl_or_b32 v48, v50, 3, v48
    v_lshl_add_u32 v49, v48, 4, v49
    v_and_b32 v50, 1, v3
    v_lshl_add_u32 v53, v50, 3, v49
    v_add_u32 v4, s56, v52
    v_add_u32 v8, s56, v53
    v_xor_b32 v5, 64, v4
    v_xor_b32 v6, 128, v4
    v_xor_b32 v7, 192, v4
    v_xor_b32 v9, 16, v8
    v_xor_b32 v10, 32, v8
    v_xor_b32 v11, 48, v8
    v_xor_b32 v12, 128, v8
    v_xor_b32 v13, 144, v8
    v_xor_b32 v14, 160, v8
    v_xor_b32 v15, 176, v8
    v_lshlrev_b32 v48, 4, v2
    v_add_u32 v49, 4, v48
    v_add_u32 v50, 8, v48
    v_add_u32 v51, 12, v48
    s_mov_b32 s10, 262144
    s_mov_b32 s14, 262144
    s_add_u32 m0, s56, 0
    s_add_u32 s31, s52, 0
    buffer_load_dwordx4 v16, s[4:7], s31 offen lds
    buffer_load_dwordx4 v17, s[4:7], s31 offen offset:1024 lds
    buffer_load_dwordx4 v16, s[4:7], s31 offen offset:2048 lds
    buffer_load_dwordx4 v17, s[4:7], s31 offen offset:3072 lds
    s_add_u32 m0, s56, 4096
    s_add_u32 s31, s52, 4096
    buffer_load_dwordx4 v16, s[4:7], s31 offen lds
    buffer_load_dwordx4 v17, s[4:7], s31 offen offset:1024 lds
    buffer_load_dwordx4 v16, s[4:7], s31 offen offset:2048 lds
    buffer_load_dwordx4 v17, s[4:7], s31 offen offset:3072 lds
    s_waitcnt vmcnt(0)
    ds_read_b128 v[64:67], v4 offset:0
    ds_read_b128 v[68:71], v5 offset:0
    ds_read_b128 v[72:75], v6 offset:0
    ds_read_b128 v[76:79], v7 offset:0
    s_waitcnt lgkmcnt(0)
    v_lshlrev_b32 v1, 16, v64
    v_and_b32 v2, 0xffff0000, v64
    v_mul_f32 v1, s26, v1
    v_mul_f32 v2, s26, v2
    v_cvt_pk_bf16_f32 v1, v1, v2
    v_accvgpr_write_b32 a0, v1
    v_lshlrev_b32 v1, 16, v65
    v_and_b32 v2, 0xffff0000, v65
    v_mul_f32 v1, s26, v1
    v_mul_f32 v2, s26, v2
    v_cvt_pk_bf16_f32 v1, v1, v2
    v_accvgpr_write_b32 a1, v1
    v_lshlrev_b32 v1, 16, v66
    v_and_b32 v2, 0xffff0000, v66
    v_mul_f32 v1, s26, v1
    v_mul_f32 v2, s26, v2
    v_cvt_pk_bf16_f32 v1, v1, v2
    v_accvgpr_write_b32 a2, v1
    v_lshlrev_b32 v1, 16, v67
    v_and_b32 v2, 0xffff0000, v67
    v_mul_f32 v1, s26, v1
    v_mul_f32 v2, s26, v2
    v_cvt_pk_bf16_f32 v1, v1, v2
    v_accvgpr_write_b32 a3, v1
    v_lshlrev_b32 v1, 16, v68
    v_and_b32 v2, 0xffff0000, v68
    v_mul_f32 v1, s26, v1
    v_mul_f32 v2, s26, v2
    v_cvt_pk_bf16_f32 v1, v1, v2
    v_accvgpr_write_b32 a4, v1
    v_lshlrev_b32 v1, 16, v69
    v_and_b32 v2, 0xffff0000, v69
    v_mul_f32 v1, s26, v1
    v_mul_f32 v2, s26, v2
    v_cvt_pk_bf16_f32 v1, v1, v2
    v_accvgpr_write_b32 a5, v1
    v_lshlrev_b32 v1, 16, v70
    v_and_b32 v2, 0xffff0000, v70
    v_mul_f32 v1, s26, v1
    v_mul_f32 v2, s26, v2
    v_cvt_pk_bf16_f32 v1, v1, v2
    v_accvgpr_write_b32 a6, v1
    v_lshlrev_b32 v1, 16, v71
    v_and_b32 v2, 0xffff0000, v71
    v_mul_f32 v1, s26, v1
    v_mul_f32 v2, s26, v2
    v_cvt_pk_bf16_f32 v1, v1, v2
    v_accvgpr_write_b32 a7, v1
    v_lshlrev_b32 v1, 16, v72
    v_and_b32 v2, 0xffff0000, v72
    v_mul_f32 v1, s26, v1
    v_mul_f32 v2, s26, v2
    v_cvt_pk_bf16_f32 v1, v1, v2
    v_accvgpr_write_b32 a8, v1
    v_lshlrev_b32 v1, 16, v73
    v_and_b32 v2, 0xffff0000, v73
    v_mul_f32 v1, s26, v1
    v_mul_f32 v2, s26, v2
    v_cvt_pk_bf16_f32 v1, v1, v2
    v_accvgpr_write_b32 a9, v1
    v_lshlrev_b32 v1, 16, v74
    v_and_b32 v2, 0xffff0000, v74
    v_mul_f32 v1, s26, v1
    v_mul_f32 v2, s26, v2
    v_cvt_pk_bf16_f32 v1, v1, v2
    v_accvgpr_write_b32 a10, v1
    v_lshlrev_b32 v1, 16, v75
    v_and_b32 v2, 0xffff0000, v75
    v_mul_f32 v1, s26, v1
    v_mul_f32 v2, s26, v2
    v_cvt_pk_bf16_f32 v1, v1, v2
    v_accvgpr_write_b32 a11, v1
    v_lshlrev_b32 v1, 16, v76
    v_and_b32 v2, 0xffff0000, v76
    v_mul_f32 v1, s26, v1
    v_mul_f32 v2, s26, v2
    v_cvt_pk_bf16_f32 v1, v1, v2
    v_accvgpr_write_b32 a12, v1
    v_lshlrev_b32 v1, 16, v77
    v_and_b32 v2, 0xffff0000, v77
    v_mul_f32 v1, s26, v1
    v_mul_f32 v2, s26, v2
    v_cvt_pk_bf16_f32 v1, v1, v2
    v_accvgpr_write_b32 a13, v1
    v_lshlrev_b32 v1, 16, v78
    v_and_b32 v2, 0xffff0000, v78
    v_mul_f32 v1, s26, v1
    v_mul_f32 v2, s26, v2
    v_cvt_pk_bf16_f32 v1, v1, v2
    v_accvgpr_write_b32 a14, v1
    v_lshlrev_b32 v1, 16, v79
    v_and_b32 v2, 0xffff0000, v79
    v_mul_f32 v1, s26, v1
    v_mul_f32 v2, s26, v2
    v_cvt_pk_bf16_f32 v1, v1, v2
    v_accvgpr_write_b32 a15, v1
    ds_read_b128 v[64:67], v4 offset:4096
    ds_read_b128 v[68:71], v5 offset:4096
    ds_read_b128 v[72:75], v6 offset:4096
    ds_read_b128 v[76:79], v7 offset:4096
    s_waitcnt lgkmcnt(0)
    v_lshlrev_b32 v1, 16, v64
    v_and_b32 v2, 0xffff0000, v64
    v_mul_f32 v1, s26, v1
    v_mul_f32 v2, s26, v2
    v_cvt_pk_bf16_f32 v1, v1, v2
    v_accvgpr_write_b32 a16, v1
    v_lshlrev_b32 v1, 16, v65
    v_and_b32 v2, 0xffff0000, v65
    v_mul_f32 v1, s26, v1
    v_mul_f32 v2, s26, v2
    v_cvt_pk_bf16_f32 v1, v1, v2
    v_accvgpr_write_b32 a17, v1
    v_lshlrev_b32 v1, 16, v66
    v_and_b32 v2, 0xffff0000, v66
    v_mul_f32 v1, s26, v1
    v_mul_f32 v2, s26, v2
    v_cvt_pk_bf16_f32 v1, v1, v2
    v_accvgpr_write_b32 a18, v1
    v_lshlrev_b32 v1, 16, v67
    v_and_b32 v2, 0xffff0000, v67
    v_mul_f32 v1, s26, v1
    v_mul_f32 v2, s26, v2
    v_cvt_pk_bf16_f32 v1, v1, v2
    v_accvgpr_write_b32 a19, v1
    v_lshlrev_b32 v1, 16, v68
    v_and_b32 v2, 0xffff0000, v68
    v_mul_f32 v1, s26, v1
    v_mul_f32 v2, s26, v2
    v_cvt_pk_bf16_f32 v1, v1, v2
    v_accvgpr_write_b32 a20, v1
    v_lshlrev_b32 v1, 16, v69
    v_and_b32 v2, 0xffff0000, v69
    v_mul_f32 v1, s26, v1
    v_mul_f32 v2, s26, v2
    v_cvt_pk_bf16_f32 v1, v1, v2
    v_accvgpr_write_b32 a21, v1
    v_lshlrev_b32 v1, 16, v70
    v_and_b32 v2, 0xffff0000, v70
    v_mul_f32 v1, s26, v1
    v_mul_f32 v2, s26, v2
    v_cvt_pk_bf16_f32 v1, v1, v2
    v_accvgpr_write_b32 a22, v1
    v_lshlrev_b32 v1, 16, v71
    v_and_b32 v2, 0xffff0000, v71
    v_mul_f32 v1, s26, v1
    v_mul_f32 v2, s26, v2
    v_cvt_pk_bf16_f32 v1, v1, v2
    v_accvgpr_write_b32 a23, v1
    v_lshlrev_b32 v1, 16, v72
    v_and_b32 v2, 0xffff0000, v72
    v_mul_f32 v1, s26, v1
    v_mul_f32 v2, s26, v2
    v_cvt_pk_bf16_f32 v1, v1, v2
    v_accvgpr_write_b32 a24, v1
    v_lshlrev_b32 v1, 16, v73
    v_and_b32 v2, 0xffff0000, v73
    v_mul_f32 v1, s26, v1
    v_mul_f32 v2, s26, v2
    v_cvt_pk_bf16_f32 v1, v1, v2
    v_accvgpr_write_b32 a25, v1
    v_lshlrev_b32 v1, 16, v74
    v_and_b32 v2, 0xffff0000, v74
    v_mul_f32 v1, s26, v1
    v_mul_f32 v2, s26, v2
    v_cvt_pk_bf16_f32 v1, v1, v2
    v_accvgpr_write_b32 a26, v1
    v_lshlrev_b32 v1, 16, v75
    v_and_b32 v2, 0xffff0000, v75
    v_mul_f32 v1, s26, v1
    v_mul_f32 v2, s26, v2
    v_cvt_pk_bf16_f32 v1, v1, v2
    v_accvgpr_write_b32 a27, v1
    v_lshlrev_b32 v1, 16, v76
    v_and_b32 v2, 0xffff0000, v76
    v_mul_f32 v1, s26, v1
    v_mul_f32 v2, s26, v2
    v_cvt_pk_bf16_f32 v1, v1, v2
    v_accvgpr_write_b32 a28, v1
    v_lshlrev_b32 v1, 16, v77
    v_and_b32 v2, 0xffff0000, v77
    v_mul_f32 v1, s26, v1
    v_mul_f32 v2, s26, v2
    v_cvt_pk_bf16_f32 v1, v1, v2
    v_accvgpr_write_b32 a29, v1
    v_lshlrev_b32 v1, 16, v78
    v_and_b32 v2, 0xffff0000, v78
    v_mul_f32 v1, s26, v1
    v_mul_f32 v2, s26, v2
    v_cvt_pk_bf16_f32 v1, v1, v2
    v_accvgpr_write_b32 a30, v1
    v_lshlrev_b32 v1, 16, v79
    v_and_b32 v2, 0xffff0000, v79
    v_mul_f32 v1, s26, v1
    v_mul_f32 v2, s26, v2
    v_cvt_pk_bf16_f32 v1, v1, v2
    v_accvgpr_write_b32 a31, v1
    s_add_u32 m0, s56, 0
    s_add_u32 s31, s54, 0
    buffer_load_dwordx4 v16, s[4:7], s31 offen lds
    buffer_load_dwordx4 v17, s[4:7], s31 offen offset:1024 lds
    buffer_load_dwordx4 v16, s[4:7], s31 offen offset:2048 lds
    buffer_load_dwordx4 v17, s[4:7], s31 offen offset:3072 lds
    s_add_u32 m0, s56, 4096
    s_add_u32 s31, s54, 4096
    buffer_load_dwordx4 v16, s[4:7], s31 offen lds
    buffer_load_dwordx4 v17, s[4:7], s31 offen offset:1024 lds
    buffer_load_dwordx4 v16, s[4:7], s31 offen offset:2048 lds
    buffer_load_dwordx4 v17, s[4:7], s31 offen offset:3072 lds
    s_waitcnt vmcnt(0)
    ds_read_b128 v[64:67], v4 offset:0
    ds_read_b128 v[68:71], v5 offset:0
    ds_read_b128 v[72:75], v6 offset:0
    ds_read_b128 v[76:79], v7 offset:0
    s_waitcnt lgkmcnt(0)
    v_lshlrev_b32 v1, 16, v64
    v_and_b32 v2, 0xffff0000, v64
    v_mul_f32 v1, s26, v1
    v_mul_f32 v2, s26, v2
    v_cvt_pk_bf16_f32 v1, v1, v2
    v_accvgpr_write_b32 a32, v1
    v_lshlrev_b32 v1, 16, v65
    v_and_b32 v2, 0xffff0000, v65
    v_mul_f32 v1, s26, v1
    v_mul_f32 v2, s26, v2
    v_cvt_pk_bf16_f32 v1, v1, v2
    v_accvgpr_write_b32 a33, v1
    v_lshlrev_b32 v1, 16, v66
    v_and_b32 v2, 0xffff0000, v66
    v_mul_f32 v1, s26, v1
    v_mul_f32 v2, s26, v2
    v_cvt_pk_bf16_f32 v1, v1, v2
    v_accvgpr_write_b32 a34, v1
    v_lshlrev_b32 v1, 16, v67
    v_and_b32 v2, 0xffff0000, v67
    v_mul_f32 v1, s26, v1
    v_mul_f32 v2, s26, v2
    v_cvt_pk_bf16_f32 v1, v1, v2
    v_accvgpr_write_b32 a35, v1
    v_lshlrev_b32 v1, 16, v68
    v_and_b32 v2, 0xffff0000, v68
    v_mul_f32 v1, s26, v1
    v_mul_f32 v2, s26, v2
    v_cvt_pk_bf16_f32 v1, v1, v2
    v_accvgpr_write_b32 a36, v1
    v_lshlrev_b32 v1, 16, v69
    v_and_b32 v2, 0xffff0000, v69
    v_mul_f32 v1, s26, v1
    v_mul_f32 v2, s26, v2
    v_cvt_pk_bf16_f32 v1, v1, v2
    v_accvgpr_write_b32 a37, v1
    v_lshlrev_b32 v1, 16, v70
    v_and_b32 v2, 0xffff0000, v70
    v_mul_f32 v1, s26, v1
    v_mul_f32 v2, s26, v2
    v_cvt_pk_bf16_f32 v1, v1, v2
    v_accvgpr_write_b32 a38, v1
    v_lshlrev_b32 v1, 16, v71
    v_and_b32 v2, 0xffff0000, v71
    v_mul_f32 v1, s26, v1
    v_mul_f32 v2, s26, v2
    v_cvt_pk_bf16_f32 v1, v1, v2
    v_accvgpr_write_b32 a39, v1
    v_lshlrev_b32 v1, 16, v72
    v_and_b32 v2, 0xffff0000, v72
    v_mul_f32 v1, s26, v1
    v_mul_f32 v2, s26, v2
    v_cvt_pk_bf16_f32 v1, v1, v2
    v_accvgpr_write_b32 a40, v1
    v_lshlrev_b32 v1, 16, v73
    v_and_b32 v2, 0xffff0000, v73
    v_mul_f32 v1, s26, v1
    v_mul_f32 v2, s26, v2
    v_cvt_pk_bf16_f32 v1, v1, v2
    v_accvgpr_write_b32 a41, v1
    v_lshlrev_b32 v1, 16, v74
    v_and_b32 v2, 0xffff0000, v74
    v_mul_f32 v1, s26, v1
    v_mul_f32 v2, s26, v2
    v_cvt_pk_bf16_f32 v1, v1, v2
    v_accvgpr_write_b32 a42, v1
    v_lshlrev_b32 v1, 16, v75
    v_and_b32 v2, 0xffff0000, v75
    v_mul_f32 v1, s26, v1
    v_mul_f32 v2, s26, v2
    v_cvt_pk_bf16_f32 v1, v1, v2
    v_accvgpr_write_b32 a43, v1
    v_lshlrev_b32 v1, 16, v76
    v_and_b32 v2, 0xffff0000, v76
    v_mul_f32 v1, s26, v1
    v_mul_f32 v2, s26, v2
    v_cvt_pk_bf16_f32 v1, v1, v2
    v_accvgpr_write_b32 a44, v1
    v_lshlrev_b32 v1, 16, v77
    v_and_b32 v2, 0xffff0000, v77
    v_mul_f32 v1, s26, v1
    v_mul_f32 v2, s26, v2
    v_cvt_pk_bf16_f32 v1, v1, v2
    v_accvgpr_write_b32 a45, v1
    v_lshlrev_b32 v1, 16, v78
    v_and_b32 v2, 0xffff0000, v78
    v_mul_f32 v1, s26, v1
    v_mul_f32 v2, s26, v2
    v_cvt_pk_bf16_f32 v1, v1, v2
    v_accvgpr_write_b32 a46, v1
    v_lshlrev_b32 v1, 16, v79
    v_and_b32 v2, 0xffff0000, v79
    v_mul_f32 v1, s26, v1
    v_mul_f32 v2, s26, v2
    v_cvt_pk_bf16_f32 v1, v1, v2
    v_accvgpr_write_b32 a47, v1
    ds_read_b128 v[64:67], v4 offset:4096
    ds_read_b128 v[68:71], v5 offset:4096
    ds_read_b128 v[72:75], v6 offset:4096
    ds_read_b128 v[76:79], v7 offset:4096
    s_waitcnt lgkmcnt(0)
    v_lshlrev_b32 v1, 16, v64
    v_and_b32 v2, 0xffff0000, v64
    v_mul_f32 v1, s26, v1
    v_mul_f32 v2, s26, v2
    v_cvt_pk_bf16_f32 v1, v1, v2
    v_accvgpr_write_b32 a48, v1
    v_lshlrev_b32 v1, 16, v65
    v_and_b32 v2, 0xffff0000, v65
    v_mul_f32 v1, s26, v1
    v_mul_f32 v2, s26, v2
    v_cvt_pk_bf16_f32 v1, v1, v2
    v_accvgpr_write_b32 a49, v1
    v_lshlrev_b32 v1, 16, v66
    v_and_b32 v2, 0xffff0000, v66
    v_mul_f32 v1, s26, v1
    v_mul_f32 v2, s26, v2
    v_cvt_pk_bf16_f32 v1, v1, v2
    v_accvgpr_write_b32 a50, v1
    v_lshlrev_b32 v1, 16, v67
    v_and_b32 v2, 0xffff0000, v67
    v_mul_f32 v1, s26, v1
    v_mul_f32 v2, s26, v2
    v_cvt_pk_bf16_f32 v1, v1, v2
    v_accvgpr_write_b32 a51, v1
    v_lshlrev_b32 v1, 16, v68
    v_and_b32 v2, 0xffff0000, v68
    v_mul_f32 v1, s26, v1
    v_mul_f32 v2, s26, v2
    v_cvt_pk_bf16_f32 v1, v1, v2
    v_accvgpr_write_b32 a52, v1
    v_lshlrev_b32 v1, 16, v69
    v_and_b32 v2, 0xffff0000, v69
    v_mul_f32 v1, s26, v1
    v_mul_f32 v2, s26, v2
    v_cvt_pk_bf16_f32 v1, v1, v2
    v_accvgpr_write_b32 a53, v1
    v_lshlrev_b32 v1, 16, v70
    v_and_b32 v2, 0xffff0000, v70
    v_mul_f32 v1, s26, v1
    v_mul_f32 v2, s26, v2
    v_cvt_pk_bf16_f32 v1, v1, v2
    v_accvgpr_write_b32 a54, v1
    v_lshlrev_b32 v1, 16, v71
    v_and_b32 v2, 0xffff0000, v71
    v_mul_f32 v1, s26, v1
    v_mul_f32 v2, s26, v2
    v_cvt_pk_bf16_f32 v1, v1, v2
    v_accvgpr_write_b32 a55, v1
    v_lshlrev_b32 v1, 16, v72
    v_and_b32 v2, 0xffff0000, v72
    v_mul_f32 v1, s26, v1
    v_mul_f32 v2, s26, v2
    v_cvt_pk_bf16_f32 v1, v1, v2
    v_accvgpr_write_b32 a56, v1
    v_lshlrev_b32 v1, 16, v73
    v_and_b32 v2, 0xffff0000, v73
    v_mul_f32 v1, s26, v1
    v_mul_f32 v2, s26, v2
    v_cvt_pk_bf16_f32 v1, v1, v2
    v_accvgpr_write_b32 a57, v1
    v_lshlrev_b32 v1, 16, v74
    v_and_b32 v2, 0xffff0000, v74
    v_mul_f32 v1, s26, v1
    v_mul_f32 v2, s26, v2
    v_cvt_pk_bf16_f32 v1, v1, v2
    v_accvgpr_write_b32 a58, v1
    v_lshlrev_b32 v1, 16, v75
    v_and_b32 v2, 0xffff0000, v75
    v_mul_f32 v1, s26, v1
    v_mul_f32 v2, s26, v2
    v_cvt_pk_bf16_f32 v1, v1, v2
    v_accvgpr_write_b32 a59, v1
    v_lshlrev_b32 v1, 16, v76
    v_and_b32 v2, 0xffff0000, v76
    v_mul_f32 v1, s26, v1
    v_mul_f32 v2, s26, v2
    v_cvt_pk_bf16_f32 v1, v1, v2
    v_accvgpr_write_b32 a60, v1
    v_lshlrev_b32 v1, 16, v77
    v_and_b32 v2, 0xffff0000, v77
    v_mul_f32 v1, s26, v1
    v_mul_f32 v2, s26, v2
    v_cvt_pk_bf16_f32 v1, v1, v2
    v_accvgpr_write_b32 a61, v1
    v_lshlrev_b32 v1, 16, v78
    v_and_b32 v2, 0xffff0000, v78
    v_mul_f32 v1, s26, v1
    v_mul_f32 v2, s26, v2
    v_cvt_pk_bf16_f32 v1, v1, v2
    v_accvgpr_write_b32 a62, v1
    v_lshlrev_b32 v1, 16, v79
    v_and_b32 v2, 0xffff0000, v79
    v_mul_f32 v1, s26, v1
    v_mul_f32 v2, s26, v2
    v_cvt_pk_bf16_f32 v1, v1, v2
    v_accvgpr_write_b32 a63, v1
    v_accvgpr_write_b32 a224, 0
    v_accvgpr_write_b32 a225, 0
    v_accvgpr_write_b32 a226, 0
    v_accvgpr_write_b32 a227, 0
    v_accvgpr_write_b32 a228, 0
    v_accvgpr_write_b32 a229, 0
    v_accvgpr_write_b32 a230, 0
    v_accvgpr_write_b32 a231, 0
    v_accvgpr_write_b32 a232, 0
    v_accvgpr_write_b32 a233, 0
    v_accvgpr_write_b32 a234, 0
    v_accvgpr_write_b32 a235, 0
    v_accvgpr_write_b32 a236, 0
    v_accvgpr_write_b32 a237, 0
    v_accvgpr_write_b32 a238, 0
    v_accvgpr_write_b32 a239, 0
    v_accvgpr_write_b32 a244, 0
    v_accvgpr_write_b32 a245, 0
    v_accvgpr_write_b32 a246, 0
    v_accvgpr_write_b32 a247, 0
    v_accvgpr_write_b32 a248, 0
    v_accvgpr_write_b32 a249, 0
    v_accvgpr_write_b32 a250, 0
    v_accvgpr_write_b32 a251, 0
    v_mov_b32 v136, 0
    v_mov_b32 v137, 0
    v_mov_b32 v138, 0
    v_mov_b32 v139, 0
    v_mov_b32 v140, 0
    v_mov_b32 v141, 0
    v_mov_b32 v142, 0
    v_mov_b32 v143, 0
    v_mov_b32 v144, 0
    v_mov_b32 v145, 0
    v_mov_b32 v146, 0
    v_mov_b32 v147, 0
    v_mov_b32 v148, 0
    v_mov_b32 v149, 0
    v_mov_b32 v150, 0
    v_mov_b32 v151, 0
    v_mov_b32 v152, 0
    v_mov_b32 v153, 0
    v_mov_b32 v154, 0
    v_mov_b32 v155, 0
    v_mov_b32 v156, 0
    v_mov_b32 v157, 0
    v_mov_b32 v158, 0
    v_mov_b32 v159, 0
    v_mov_b32 v160, 0
    v_mov_b32 v161, 0
    v_mov_b32 v162, 0
    v_mov_b32 v163, 0
    v_mov_b32 v164, 0
    v_mov_b32 v165, 0
    v_mov_b32 v166, 0
    v_mov_b32 v167, 0
    v_mov_b32 v168, 0
    v_mov_b32 v169, 0
    v_mov_b32 v170, 0
    v_mov_b32 v171, 0
    v_mov_b32 v172, 0
    v_mov_b32 v173, 0
    v_mov_b32 v174, 0
    v_mov_b32 v175, 0
    v_mov_b32 v176, 0
    v_mov_b32 v177, 0
    v_mov_b32 v178, 0
    v_mov_b32 v179, 0
    v_mov_b32 v180, 0
    v_mov_b32 v181, 0
    v_mov_b32 v182, 0
    v_mov_b32 v183, 0
    v_mov_b32 v184, 0
    v_mov_b32 v185, 0
    v_mov_b32 v186, 0
    v_mov_b32 v187, 0
    v_mov_b32 v188, 0
    v_mov_b32 v189, 0
    v_mov_b32 v190, 0
    v_mov_b32 v191, 0
    v_mov_b32 v192, 0
    v_mov_b32 v193, 0
    v_mov_b32 v194, 0
    v_mov_b32 v195, 0
    v_mov_b32 v196, 0
    v_mov_b32 v197, 0
    v_mov_b32 v198, 0
    v_mov_b32 v199, 0
    v_mov_b32 v200, 0
    v_mov_b32 v201, 0
    v_mov_b32 v202, 0
    v_mov_b32 v203, 0
    v_mov_b32 v204, 0
    v_mov_b32 v205, 0
    v_mov_b32 v206, 0
    v_mov_b32 v207, 0
    v_mov_b32 v208, 0
    v_mov_b32 v209, 0
    v_mov_b32 v210, 0
    v_mov_b32 v211, 0
    v_mov_b32 v212, 0
    v_mov_b32 v213, 0
    v_mov_b32 v214, 0
    v_mov_b32 v215, 0
    v_mov_b32 v216, 0
    v_mov_b32 v217, 0
    v_mov_b32 v218, 0
    v_mov_b32 v219, 0
    v_mov_b32 v220, 0
    v_mov_b32 v221, 0
    v_mov_b32 v222, 0
    v_mov_b32 v223, 0
    v_mov_b32 v224, 0
    v_mov_b32 v225, 0
    v_mov_b32 v226, 0
    v_mov_b32 v227, 0
    v_mov_b32 v228, 0
    v_mov_b32 v229, 0
    v_mov_b32 v230, 0
    v_mov_b32 v231, 0
    v_mov_b32 v232, 0
    v_mov_b32 v233, 0
    v_mov_b32 v234, 0
    v_mov_b32 v235, 0
    v_mov_b32 v236, 0
    v_mov_b32 v237, 0
    v_mov_b32 v238, 0
    v_mov_b32 v239, 0
    v_mov_b32 v240, 0
    v_mov_b32 v241, 0
    v_mov_b32 v242, 0
    v_mov_b32 v243, 0
    v_mov_b32 v244, 0
    v_mov_b32 v245, 0
    v_mov_b32 v246, 0
    v_mov_b32 v247, 0
    v_mov_b32 v248, 0
    v_mov_b32 v249, 0
    v_mov_b32 v250, 0
    v_mov_b32 v251, 0
    v_mov_b32 v252, 0
    v_mov_b32 v253, 0
    v_mov_b32 v254, 0
    v_mov_b32 v255, 0
    v_mov_b32 v24, 0xff7fffff
    v_mov_b32 v25, 0xff7fffff
    v_mov_b32 v26, 0xff7fffff
    v_mov_b32 v27, 0xff7fffff
    s_mov_b32 s22, 0
L_slow_loop:
    s_add_u32 m0, s56, 0
    s_add_u32 s31, s22, 0
    buffer_load_dwordx4 v16, s[8:11], s31 offen lds
    buffer_load_dwordx4 v17, s[8:11], s31 offen offset:1024 lds
    buffer_load_dwordx4 v16, s[8:11], s31 offen offset:2048 lds
    buffer_load_dwordx4 v17, s[8:11], s31 offen offset:3072 lds
    s_add_u32 m0, s56, 4096
    s_add_u32 s31, s22, 4096
    buffer_load_dwordx4 v16, s[8:11], s31 offen lds
    buffer_load_dwordx4 v17, s[8:11], s31 offen offset:1024 lds
    buffer_load_dwordx4 v16, s[8:11], s31 offen offset:2048 lds
    buffer_load_dwordx4 v17, s[8:11], s31 offen offset:3072 lds
    s_waitcnt vmcnt(0)
    ds_read_b128 a[64:67], v4 offset:0
    ds_read_b128 a[68:71], v5 offset:0
    ds_read_b128 a[72:75], v6 offset:0
    ds_read_b128 a[76:79], v7 offset:0
    ds_read_b128 a[80:83], v4 offset:4096
    ds_read_b128 a[84:87], v5 offset:4096
    ds_read_b128 a[88:91], v6 offset:4096
    ds_read_b128 a[92:95], v7 offset:4096
    s_waitcnt lgkmcnt(0)
    s_add_u32 m0, s56, 0
    s_add_u32 s31, s22, 0
    buffer_load_dwordx4 v20, s[12:15], s31 offen lds
    buffer_load_dwordx4 v21, s[12:15], s31 offen offset:1024 lds
    buffer_load_dwordx4 v20, s[12:15], s31 offen offset:2048 lds
    buffer_load_dwordx4 v21, s[12:15], s31 offen offset:3072 lds
    s_add_u32 m0, s56, 4096
    s_add_u32 s31, s22, 4096
    buffer_load_dwordx4 v20, s[12:15], s31 offen lds
    buffer_load_dwordx4 v21, s[12:15], s31 offen offset:1024 lds
    buffer_load_dwordx4 v20, s[12:15], s31 offen offset:2048 lds
    buffer_load_dwordx4 v21, s[12:15], s31 offen offset:3072 lds
    s_waitcnt vmcnt(0)
    ds_read_b64_tr_b16 a[96:97], v8 offset:0
    ds_read_b64_tr_b16 a[98:99], v8 offset:4096
    ds_read_b64_tr_b16 a[100:101], v9 offset:0
    ds_read_b64_tr_b16 a[102:103], v9 offset:4096
    ds_read_b64_tr_b16 a[104:105], v10 offset:0
    ds_read_b64_tr_b16 a[106:107], v10 offset:4096
    ds_read_b64_tr_b16 a[108:109], v11 offset:0
    ds_read_b64_tr_b16 a[110:111], v11 offset:4096
    s_waitcnt lgkmcnt(0)
    ds_read_b64_tr_b16 a[112:113], v12 offset:0
    ds_read_b64_tr_b16 a[114:115], v12 offset:4096
    ds_read_b64_tr_b16 a[116:117], v13 offset:0
    ds_read_b64_tr_b16 a[118:119], v13 offset:4096
    ds_read_b64_tr_b16 a[120:121], v14 offset:0
    ds_read_b64_tr_b16 a[122:123], v14 offset:4096
    ds_read_b64_tr_b16 a[124:125], v15 offset:0
    ds_read_b64_tr_b16 a[126:127], v15 offset:4096
    v_mfma_f32_16x16x32_bf16 v[40:43], a[64:67], a[0:3], 0
    v_mfma_f32_16x16x32_bf16 v[40:43], a[68:71], a[4:7], v[40:43]
    v_mfma_f32_16x16x32_bf16 v[40:43], a[72:75], a[8:11], v[40:43]
    v_mfma_f32_16x16x32_bf16 v[40:43], a[76:79], a[12:15], v[40:43]
    v_mfma_f32_16x16x32_bf16 v[44:47], a[80:83], a[0:3], 0
    v_mfma_f32_16x16x32_bf16 v[44:47], a[84:87], a[4:7], v[44:47]
    v_mfma_f32_16x16x32_bf16 v[44:47], a[88:91], a[8:11], v[44:47]
    v_mfma_f32_16x16x32_bf16 v[44:47], a[92:95], a[12:15], v[44:47]
    v_mfma_f32_16x16x32_bf16 v[64:67], a[64:67], a[16:19], 0
    v_mfma_f32_16x16x32_bf16 v[64:67], a[68:71], a[20:23], v[64:67]
    v_mfma_f32_16x16x32_bf16 v[64:67], a[72:75], a[24:27], v[64:67]
    v_mfma_f32_16x16x32_bf16 v[64:67], a[76:79], a[28:31], v[64:67]
    v_mfma_f32_16x16x32_bf16 v[68:71], a[80:83], a[16:19], 0
    v_mfma_f32_16x16x32_bf16 v[68:71], a[84:87], a[20:23], v[68:71]
    v_mfma_f32_16x16x32_bf16 v[68:71], a[88:91], a[24:27], v[68:71]
    v_mfma_f32_16x16x32_bf16 v[68:71], a[92:95], a[28:31], v[68:71]
    v_mfma_f32_16x16x32_bf16 v[88:91], a[64:67], a[32:35], 0
    v_mfma_f32_16x16x32_bf16 v[88:91], a[68:71], a[36:39], v[88:91]
    v_mfma_f32_16x16x32_bf16 v[88:91], a[72:75], a[40:43], v[88:91]
    v_mfma_f32_16x16x32_bf16 v[88:91], a[76:79], a[44:47], v[88:91]
    v_mfma_f32_16x16x32_bf16 v[92:95], a[80:83], a[32:35], 0
    v_mfma_f32_16x16x32_bf16 v[92:95], a[84:87], a[36:39], v[92:95]
    v_mfma_f32_16x16x32_bf16 v[92:95], a[88:91], a[40:43], v[92:95]
    v_mfma_f32_16x16x32_bf16 v[92:95], a[92:95], a[44:47], v[92:95]
    v_mfma_f32_16x16x32_bf16 v[112:115], a[64:67], a[48:51], 0
    v_mfma_f32_16x16x32_bf16 v[112:115], a[68:71], a[52:55], v[112:115]
    v_mfma_f32_16x16x32_bf16 v[112:115], a[72:75], a[56:59], v[112:115]
    v_mfma_f32_16x16x32_bf16 v[112:115], a[76:79], a[60:63], v[112:115]
    v_mfma_f32_16x16x32_bf16 v[116:119], a[80:83], a[48:51], 0
    v_mfma_f32_16x16x32_bf16 v[116:119], a[84:87], a[52:55], v[116:119]
    v_mfma_f32_16x16x32_bf16 v[116:119], a[88:91], a[56:59], v[116:119]
    v_mfma_f32_16x16x32_bf16 v[116:119], a[92:95], a[60:63], v[116:119]
    s_waitcnt lgkmcnt(0)
    s_nop 7
    s_nop 1
    v_max3_f32 v1, v40, v41, v42
    v_max3_f32 v1, v43, v44, v1
    v_max3_f32 v1, v45, v46, v1
    v_max3_f32 v1, v47, v24, v1
    v_mov_b32 v2, v1
    s_nop 1
    v_permlane16_swap_b32 v2, v1
    s_nop 1
    v_max_f32 v1, v2, v1
    v_mov_b32 v2, v1
    s_nop 1
    v_permlane32_swap_b32 v2, v1
    s_nop 1
    v_max_f32 v1, v2, v1
    v_sub_f32 v3, v24, v1
    v_exp_f32 v3, v3
    v_mov_b32 v24, v1
    ds_bpermute_b32 v52, v48, v3
    ds_bpermute_b32 v53, v49, v3
    ds_bpermute_b32 v54, v50, v3
    ds_bpermute_b32 v55, v51, v3
    v_sub_f32 v40, v40, v1
    v_sub_f32 v41, v41, v1
    v_sub_f32 v42, v42, v1
    v_sub_f32 v43, v43, v1
    v_sub_f32 v44, v44, v1
    v_sub_f32 v45, v45, v1
    v_sub_f32 v46, v46, v1
    v_sub_f32 v47, v47, v1
    v_exp_f32 v40, v40
    v_exp_f32 v41, v41
    v_exp_f32 v42, v42
    v_exp_f32 v43, v43
    v_exp_f32 v44, v44
    v_exp_f32 v45, v45
    v_exp_f32 v46, v46
    v_exp_f32 v47, v47
    s_waitcnt lgkmcnt(0)
    v_mul_f32 v136, v52, v136
    v_mul_f32 v137, v53, v137
    v_mul_f32 v138, v54, v138
    v_mul_f32 v139, v55, v139
    v_mul_f32 v152, v52, v152
    v_mul_f32 v153, v53, v153
    v_mul_f32 v154, v54, v154
    v_mul_f32 v155, v55, v155
    v_mul_f32 v168, v52, v168
    v_mul_f32 v169, v53, v169
    v_mul_f32 v170, v54, v170
    v_mul_f32 v171, v55, v171
    v_mul_f32 v184, v52, v184
    v_mul_f32 v185, v53, v185
    v_mul_f32 v186, v54, v186
    v_mul_f32 v187, v55, v187
    v_mul_f32 v200, v52, v200
    v_mul_f32 v201, v53, v201
    v_mul_f32 v202, v54, v202
    v_mul_f32 v203, v55, v203
    v_mul_f32 v216, v52, v216
    v_mul_f32 v217, v53, v217
    v_mul_f32 v218, v54, v218
    v_mul_f32 v219, v55, v219
    v_accvgpr_read_b32 v2, a244
    v_mul_f32 v2, v52, v2
    v_accvgpr_write_b32 a244, v2
    v_accvgpr_read_b32 v2, a245
    v_mul_f32 v2, v53, v2
    v_accvgpr_write_b32 a245, v2
    v_accvgpr_read_b32 v2, a246
    v_mul_f32 v2, v54, v2
    v_accvgpr_write_b32 a246, v2
    v_accvgpr_read_b32 v2, a247
    v_mul_f32 v2, v55, v2
    v_accvgpr_write_b32 a247, v2
    v_accvgpr_read_b32 v2, a248
    v_mul_f32 v2, v52, v2
    v_accvgpr_write_b32 a248, v2
    v_accvgpr_read_b32 v2, a249
    v_mul_f32 v2, v53, v2
    v_accvgpr_write_b32 a249, v2
    v_accvgpr_read_b32 v2, a250
    v_mul_f32 v2, v54, v2
    v_accvgpr_write_b32 a250, v2
    v_accvgpr_read_b32 v2, a251
    v_mul_f32 v2, v55, v2
    v_accvgpr_write_b32 a251, v2
    v_accvgpr_read_b32 v2, a224
    v_mul_f32 v2, v52, v2
    v_accvgpr_write_b32 a224, v2
    v_accvgpr_read_b32 v2, a225
    v_mul_f32 v2, v53, v2
    v_accvgpr_write_b32 a225, v2
    v_accvgpr_read_b32 v2, a226
    v_mul_f32 v2, v54, v2
    v_accvgpr_write_b32 a226, v2
    v_accvgpr_read_b32 v2, a227
    v_mul_f32 v2, v55, v2
    v_accvgpr_write_b32 a227, v2
    v_cvt_pk_bf16_f32 v40, v40, v41
    v_cvt_pk_bf16_f32 v41, v42, v43
    v_cvt_pk_bf16_f32 v42, v44, v45
    v_cvt_pk_bf16_f32 v43, v46, v47
    v_max3_f32 v1, v64, v65, v66
    v_max3_f32 v1, v67, v68, v1
    v_max3_f32 v1, v69, v70, v1
    v_max3_f32 v1, v71, v25, v1
    v_mov_b32 v2, v1
    s_nop 1
    v_permlane16_swap_b32 v2, v1
    s_nop 1
    v_max_f32 v1, v2, v1
    v_mov_b32 v2, v1
    s_nop 1
    v_permlane32_swap_b32 v2, v1
    s_nop 1
    v_max_f32 v1, v2, v1
    v_sub_f32 v3, v25, v1
    v_exp_f32 v3, v3
    v_mov_b32 v25, v1
    ds_bpermute_b32 v52, v48, v3
    ds_bpermute_b32 v53, v49, v3
    ds_bpermute_b32 v54, v50, v3
    ds_bpermute_b32 v55, v51, v3
    v_sub_f32 v64, v64, v1
    v_sub_f32 v65, v65, v1
    v_sub_f32 v66, v66, v1
    v_sub_f32 v67, v67, v1
    v_sub_f32 v68, v68, v1
    v_sub_f32 v69, v69, v1
    v_sub_f32 v70, v70, v1
    v_sub_f32 v71, v71, v1
    v_exp_f32 v64, v64
    v_exp_f32 v65, v65
    v_exp_f32 v66, v66
    v_exp_f32 v67, v67
    v_exp_f32 v68, v68
    v_exp_f32 v69, v69
    v_exp_f32 v70, v70
    v_exp_f32 v71, v71
    s_waitcnt lgkmcnt(0)
    v_mul_f32 v140, v52, v140
    v_mul_f32 v141, v53, v141
    v_mul_f32 v142, v54, v142
    v_mul_f32 v143, v55, v143
    v_mul_f32 v156, v52, v156
    v_mul_f32 v157, v53, v157
    v_mul_f32 v158, v54, v158
    v_mul_f32 v159, v55, v159
    v_mul_f32 v172, v52, v172
    v_mul_f32 v173, v53, v173
    v_mul_f32 v174, v54, v174
    v_mul_f32 v175, v55, v175
    v_mul_f32 v188, v52, v188
    v_mul_f32 v189, v53, v189
    v_mul_f32 v190, v54, v190
    v_mul_f32 v191, v55, v191
    v_mul_f32 v204, v52, v204
    v_mul_f32 v205, v53, v205
    v_mul_f32 v206, v54, v206
    v_mul_f32 v207, v55, v207
    v_mul_f32 v220, v52, v220
    v_mul_f32 v221, v53, v221
    v_mul_f32 v222, v54, v222
    v_mul_f32 v223, v55, v223
    v_mul_f32 v232, v52, v232
    v_mul_f32 v233, v53, v233
    v_mul_f32 v234, v54, v234
    v_mul_f32 v235, v55, v235
    v_mul_f32 v244, v52, v244
    v_mul_f32 v245, v53, v245
    v_mul_f32 v246, v54, v246
    v_mul_f32 v247, v55, v247
    v_accvgpr_read_b32 v2, a228
    v_mul_f32 v2, v52, v2
    v_accvgpr_write_b32 a228, v2
    v_accvgpr_read_b32 v2, a229
    v_mul_f32 v2, v53, v2
    v_accvgpr_write_b32 a229, v2
    v_accvgpr_read_b32 v2, a230
    v_mul_f32 v2, v54, v2
    v_accvgpr_write_b32 a230, v2
    v_accvgpr_read_b32 v2, a231
    v_mul_f32 v2, v55, v2
    v_accvgpr_write_b32 a231, v2
    v_cvt_pk_bf16_f32 v64, v64, v65
    v_cvt_pk_bf16_f32 v65, v66, v67
    v_cvt_pk_bf16_f32 v66, v68, v69
    v_cvt_pk_bf16_f32 v67, v70, v71
    v_max3_f32 v1, v88, v89, v90
    v_max3_f32 v1, v91, v92, v1
    v_max3_f32 v1, v93, v94, v1
    v_max3_f32 v1, v95, v26, v1
    v_mov_b32 v2, v1
    s_nop 1
    v_permlane16_swap_b32 v2, v1
    s_nop 1
    v_max_f32 v1, v2, v1
    v_mov_b32 v2, v1
    s_nop 1
    v_permlane32_swap_b32 v2, v1
    s_nop 1
    v_max_f32 v1, v2, v1
    v_sub_f32 v3, v26, v1
    v_exp_f32 v3, v3
    v_mov_b32 v26, v1
    ds_bpermute_b32 v52, v48, v3
    ds_bpermute_b32 v53, v49, v3
    ds_bpermute_b32 v54, v50, v3
    ds_bpermute_b32 v55, v51, v3
    v_sub_f32 v88, v88, v1
    v_sub_f32 v89, v89, v1
    v_sub_f32 v90, v90, v1
    v_sub_f32 v91, v91, v1
    v_sub_f32 v92, v92, v1
    v_sub_f32 v93, v93, v1
    v_sub_f32 v94, v94, v1
    v_sub_f32 v95, v95, v1
    v_exp_f32 v88, v88
    v_exp_f32 v89, v89
    v_exp_f32 v90, v90
    v_exp_f32 v91, v91
    v_exp_f32 v92, v92
    v_exp_f32 v93, v93
    v_exp_f32 v94, v94
    v_exp_f32 v95, v95
    s_waitcnt lgkmcnt(0)
    v_mul_f32 v144, v52, v144
    v_mul_f32 v145, v53, v145
    v_mul_f32 v146, v54, v146
    v_mul_f32 v147, v55, v147
    v_mul_f32 v160, v52, v160
    v_mul_f32 v161, v53, v161
    v_mul_f32 v162, v54, v162
    v_mul_f32 v163, v55, v163
    v_mul_f32 v176, v52, v176
    v_mul_f32 v177, v53, v177
    v_mul_f32 v178, v54, v178
    v_mul_f32 v179, v55, v179
    v_mul_f32 v192, v52, v192
    v_mul_f32 v193, v53, v193
    v_mul_f32 v194, v54, v194
    v_mul_f32 v195, v55, v195
    v_mul_f32 v208, v52, v208
    v_mul_f32 v209, v53, v209
    v_mul_f32 v210, v54, v210
    v_mul_f32 v211, v55, v211
    v_mul_f32 v224, v52, v224
    v_mul_f32 v225, v53, v225
    v_mul_f32 v226, v54, v226
    v_mul_f32 v227, v55, v227
    v_mul_f32 v236, v52, v236
    v_mul_f32 v237, v53, v237
    v_mul_f32 v238, v54, v238
    v_mul_f32 v239, v55, v239
    v_mul_f32 v248, v52, v248
    v_mul_f32 v249, v53, v249
    v_mul_f32 v250, v54, v250
    v_mul_f32 v251, v55, v251
    v_accvgpr_read_b32 v2, a232
    v_mul_f32 v2, v52, v2
    v_accvgpr_write_b32 a232, v2
    v_accvgpr_read_b32 v2, a233
    v_mul_f32 v2, v53, v2
    v_accvgpr_write_b32 a233, v2
    v_accvgpr_read_b32 v2, a234
    v_mul_f32 v2, v54, v2
    v_accvgpr_write_b32 a234, v2
    v_accvgpr_read_b32 v2, a235
    v_mul_f32 v2, v55, v2
    v_accvgpr_write_b32 a235, v2
    v_cvt_pk_bf16_f32 v88, v88, v89
    v_cvt_pk_bf16_f32 v89, v90, v91
    v_cvt_pk_bf16_f32 v90, v92, v93
    v_cvt_pk_bf16_f32 v91, v94, v95
    v_max3_f32 v1, v112, v113, v114
    v_max3_f32 v1, v115, v116, v1
    v_max3_f32 v1, v117, v118, v1
    v_max3_f32 v1, v119, v27, v1
    v_mov_b32 v2, v1
    s_nop 1
    v_permlane16_swap_b32 v2, v1
    s_nop 1
    v_max_f32 v1, v2, v1
    v_mov_b32 v2, v1
    s_nop 1
    v_permlane32_swap_b32 v2, v1
    s_nop 1
    v_max_f32 v1, v2, v1
    v_sub_f32 v3, v27, v1
    v_exp_f32 v3, v3
    v_mov_b32 v27, v1
    ds_bpermute_b32 v52, v48, v3
    ds_bpermute_b32 v53, v49, v3
    ds_bpermute_b32 v54, v50, v3
    ds_bpermute_b32 v55, v51, v3
    v_sub_f32 v112, v112, v1
    v_sub_f32 v113, v113, v1
    v_sub_f32 v114, v114, v1
    v_sub_f32 v115, v115, v1
    v_sub_f32 v116, v116, v1
    v_sub_f32 v117, v117, v1
    v_sub_f32 v118, v118, v1
    v_sub_f32 v119, v119, v1
    v_exp_f32 v112, v112
    v_exp_f32 v113, v113
    v_exp_f32 v114, v114
    v_exp_f32 v115, v115
    v_exp_f32 v116, v116
    v_exp_f32 v117, v117
    v_exp_f32 v118, v118
    v_exp_f32 v119, v119
    s_waitcnt lgkmcnt(0)
    v_mul_f32 v148, v52, v148
    v_mul_f32 v149, v53, v149
    v_mul_f32 v150, v54, v150
    v_mul_f32 v151, v55, v151
    v_mul_f32 v164, v52, v164
    v_mul_f32 v165, v53, v165
    v_mul_f32 v166, v54, v166
    v_mul_f32 v167, v55, v167
    v_mul_f32 v180, v52, v180
    v_mul_f32 v181, v53, v181
    v_mul_f32 v182, v54, v182
    v_mul_f32 v183, v55, v183
    v_mul_f32 v196, v52, v196
    v_mul_f32 v197, v53, v197
    v_mul_f32 v198, v54, v198
    v_mul_f32 v199, v55, v199
    v_mul_f32 v212, v52, v212
    v_mul_f32 v213, v53, v213
    v_mul_f32 v214, v54, v214
    v_mul_f32 v215, v55, v215
    v_mul_f32 v228, v52, v228
    v_mul_f32 v229, v53, v229
    v_mul_f32 v230, v54, v230
    v_mul_f32 v231, v55, v231
    v_mul_f32 v240, v52, v240
    v_mul_f32 v241, v53, v241
    v_mul_f32 v242, v54, v242
    v_mul_f32 v243, v55, v243
    v_mul_f32 v252, v52, v252
    v_mul_f32 v253, v53, v253
    v_mul_f32 v254, v54, v254
    v_mul_f32 v255, v55, v255
    v_accvgpr_read_b32 v2, a236
    v_mul_f32 v2, v52, v2
    v_accvgpr_write_b32 a236, v2
    v_accvgpr_read_b32 v2, a237
    v_mul_f32 v2, v53, v2
    v_accvgpr_write_b32 a237, v2
    v_accvgpr_read_b32 v2, a238
    v_mul_f32 v2, v54, v2
    v_accvgpr_write_b32 a238, v2
    v_accvgpr_read_b32 v2, a239
    v_mul_f32 v2, v55, v2
    v_accvgpr_write_b32 a239, v2
    v_cvt_pk_bf16_f32 v112, v112, v113
    v_cvt_pk_bf16_f32 v113, v114, v115
    v_cvt_pk_bf16_f32 v114, v116, v117
    v_cvt_pk_bf16_f32 v115, v118, v119
    s_nop 1
    v_mfma_f32_16x16x32_bf16 a[224:227], v[40:43], a[240:243], a[224:227]
    v_mfma_f32_16x16x32_bf16 v[136:139], v[40:43], a[96:99], v[136:139]
    v_mfma_f32_16x16x32_bf16 v[152:155], v[40:43], a[100:103], v[152:155]
    v_mfma_f32_16x16x32_bf16 v[168:171], v[40:43], a[104:107], v[168:171]
    v_mfma_f32_16x16x32_bf16 v[184:187], v[40:43], a[108:111], v[184:187]
    v_mfma_f32_16x16x32_bf16 v[200:203], v[40:43], a[112:115], v[200:203]
    v_mfma_f32_16x16x32_bf16 v[216:219], v[40:43], a[116:119], v[216:219]
    v_mfma_f32_16x16x32_bf16 a[244:247], v[40:43], a[120:123], a[244:247]
    v_mfma_f32_16x16x32_bf16 a[248:251], v[40:43], a[124:127], a[248:251]
    v_mfma_f32_16x16x32_bf16 a[228:231], v[64:67], a[240:243], a[228:231]
    v_mfma_f32_16x16x32_bf16 v[140:143], v[64:67], a[96:99], v[140:143]
    v_mfma_f32_16x16x32_bf16 v[156:159], v[64:67], a[100:103], v[156:159]
    v_mfma_f32_16x16x32_bf16 v[172:175], v[64:67], a[104:107], v[172:175]
    v_mfma_f32_16x16x32_bf16 v[188:191], v[64:67], a[108:111], v[188:191]
    v_mfma_f32_16x16x32_bf16 v[204:207], v[64:67], a[112:115], v[204:207]
    v_mfma_f32_16x16x32_bf16 v[220:223], v[64:67], a[116:119], v[220:223]
    v_mfma_f32_16x16x32_bf16 v[232:235], v[64:67], a[120:123], v[232:235]
    v_mfma_f32_16x16x32_bf16 v[244:247], v[64:67], a[124:127], v[244:247]
    v_mfma_f32_16x16x32_bf16 a[232:235], v[88:91], a[240:243], a[232:235]
    v_mfma_f32_16x16x32_bf16 v[144:147], v[88:91], a[96:99], v[144:147]
    v_mfma_f32_16x16x32_bf16 v[160:163], v[88:91], a[100:103], v[160:163]
    v_mfma_f32_16x16x32_bf16 v[176:179], v[88:91], a[104:107], v[176:179]
    v_mfma_f32_16x16x32_bf16 v[192:195], v[88:91], a[108:111], v[192:195]
    v_mfma_f32_16x16x32_bf16 v[208:211], v[88:91], a[112:115], v[208:211]
    v_mfma_f32_16x16x32_bf16 v[224:227], v[88:91], a[116:119], v[224:227]
    v_mfma_f32_16x16x32_bf16 v[236:239], v[88:91], a[120:123], v[236:239]
    v_mfma_f32_16x16x32_bf16 v[248:251], v[88:91], a[124:127], v[248:251]
    v_mfma_f32_16x16x32_bf16 a[236:239], v[112:115], a[240:243], a[236:239]
    v_mfma_f32_16x16x32_bf16 v[148:151], v[112:115], a[96:99], v[148:151]
    v_mfma_f32_16x16x32_bf16 v[164:167], v[112:115], a[100:103], v[164:167]
    v_mfma_f32_16x16x32_bf16 v[180:183], v[112:115], a[104:107], v[180:183]
    v_mfma_f32_16x16x32_bf16 v[196:199], v[112:115], a[108:111], v[196:199]
    v_mfma_f32_16x16x32_bf16 v[212:215], v[112:115], a[112:115], v[212:215]
    v_mfma_f32_16x16x32_bf16 v[228:231], v[112:115], a[116:119], v[228:231]
    v_mfma_f32_16x16x32_bf16 v[240:243], v[112:115], a[120:123], v[240:243]
    v_mfma_f32_16x16x32_bf16 v[252:255], v[112:115], a[124:127], v[252:255]
    s_add_u32 s22, s22, 8192
    s_cmp_lt_u32 s22, 262144
    s_nop 7
    s_cbranch_scc1 L_slow_loop
    v_and_b32 v16, 48, v0
    v_lshlrev_b32 v16, 6, v16
    v_and_b32 v22, 15, v0
    v_lshl_or_b32 v22, v22, 4, v16
    v_and_b32 v17, 16, v0
    v_lshl_or_b32 v16, v17, 1, v16
    v_and_b32 v17, 3, v0
    v_lshl_or_b32 v16, v17, 6, v16
    v_and_b32 v17, 12, v0
    v_lshl_or_b32 v16, v17, 1, v16
    v_add_u32 v16, s56, v16
    v_xor_b32 v17, 32, v16
    v_accvgpr_read_b32 v24, a224
    v_accvgpr_read_b32 v25, a225
    v_accvgpr_read_b32 v26, a226
    v_accvgpr_read_b32 v27, a227
    v_max3_f32 v18, v24, v25, v26
    v_max_f32 v18, v27, v18
    v_rcp_f32 v24, v24
    v_rcp_f32 v25, v25
    v_rcp_f32 v26, v26
    v_rcp_f32 v27, v27
    v_accvgpr_read_b32 v56, a244
    v_accvgpr_read_b32 v57, a245
    v_accvgpr_read_b32 v58, a246
    v_accvgpr_read_b32 v59, a247
    v_accvgpr_read_b32 v60, a248
    v_accvgpr_read_b32 v61, a249
    v_accvgpr_read_b32 v62, a250
    v_accvgpr_read_b32 v63, a251
    v_pk_mul_f32 v[136:137], v[136:137], v[24:25]
    v_pk_mul_f32 v[152:153], v[152:153], v[24:25]
    v_pk_mul_f32 v[168:169], v[168:169], v[24:25]
    v_pk_mul_f32 v[184:185], v[184:185], v[24:25]
    v_pk_mul_f32 v[200:201], v[200:201], v[24:25]
    v_pk_mul_f32 v[216:217], v[216:217], v[24:25]
    v_pk_mul_f32 v[56:57], v[56:57], v[24:25]
    v_pk_mul_f32 v[60:61], v[60:61], v[24:25]
    v_cvt_pk_bf16_f32 v40, v136, v152
    v_cvt_pk_bf16_f32 v41, v168, v184
    ds_write_b64 v19, v[40:41] offset:0
    v_cvt_pk_bf16_f32 v42, v200, v216
    v_cvt_pk_bf16_f32 v43, v56, v60
    ds_write_b64 v19, v[42:43] offset:128
    ds_read_b64_tr_b16 v[40:41], v16 offset:0
    ds_read_b64_tr_b16 v[42:43], v17 offset:0
    v_cvt_pk_bf16_f32 v44, v137, v153
    v_cvt_pk_bf16_f32 v45, v169, v185
    ds_write_b64 v19, v[44:45] offset:256
    v_cvt_pk_bf16_f32 v46, v201, v217
    v_cvt_pk_bf16_f32 v47, v57, v61
    ds_write_b64 v19, v[46:47] offset:384
    ds_read_b64_tr_b16 v[44:45], v16 offset:256
    ds_read_b64_tr_b16 v[46:47], v17 offset:256
    v_pk_mul_f32 v[138:139], v[138:139], v[26:27]
    v_pk_mul_f32 v[154:155], v[154:155], v[26:27]
    v_pk_mul_f32 v[170:171], v[170:171], v[26:27]
    v_pk_mul_f32 v[186:187], v[186:187], v[26:27]
    v_pk_mul_f32 v[202:203], v[202:203], v[26:27]
    v_pk_mul_f32 v[218:219], v[218:219], v[26:27]
    v_pk_mul_f32 v[58:59], v[58:59], v[26:27]
    v_pk_mul_f32 v[62:63], v[62:63], v[26:27]
    v_cvt_pk_bf16_f32 v48, v138, v154
    v_cvt_pk_bf16_f32 v49, v170, v186
    ds_write_b64 v19, v[48:49] offset:512
    s_waitcnt lgkmcnt(5)
    buffer_store_dwordx4 v[40:43], v22, s[16:19], s52 offen nt
    v_cvt_pk_bf16_f32 v50, v202, v218
    v_cvt_pk_bf16_f32 v51, v58, v62
    ds_write_b64 v19, v[50:51] offset:640
    ds_read_b64_tr_b16 v[48:49], v16 offset:512
    ds_read_b64_tr_b16 v[50:51], v17 offset:512
    v_cvt_pk_bf16_f32 v52, v139, v155
    v_cvt_pk_bf16_f32 v53, v171, v187
    s_waitcnt lgkmcnt(4)
    buffer_store_dwordx4 v[44:47], v22, s[16:19], s52 offen offset:256 nt
    ds_write_b64 v19, v[52:53] offset:768
    v_cvt_pk_bf16_f32 v54, v203, v219
    v_cvt_pk_bf16_f32 v55, v59, v63
    ds_write_b64 v19, v[54:55] offset:896
    ds_read_b64_tr_b16 v[52:53], v16 offset:768
    ds_read_b64_tr_b16 v[54:55], v17 offset:768
    v_accvgpr_read_b32 v28, a228
    v_accvgpr_read_b32 v29, a229
    v_accvgpr_read_b32 v30, a230
    v_accvgpr_read_b32 v31, a231
    v_max3_f32 v18, v28, v29, v18
    v_max3_f32 v18, v30, v31, v18
    v_rcp_f32 v28, v28
    v_rcp_f32 v29, v29
    s_waitcnt lgkmcnt(4)
    buffer_store_dwordx4 v[48:51], v22, s[16:19], s52 offen offset:512 nt
    v_rcp_f32 v30, v30
    v_rcp_f32 v31, v31
    v_pk_mul_f32 v[140:141], v[140:141], v[28:29]
    v_pk_mul_f32 v[156:157], v[156:157], v[28:29]
    v_pk_mul_f32 v[172:173], v[172:173], v[28:29]
    v_pk_mul_f32 v[188:189], v[188:189], v[28:29]
    v_pk_mul_f32 v[204:205], v[204:205], v[28:29]
    v_pk_mul_f32 v[220:221], v[220:221], v[28:29]
    v_pk_mul_f32 v[232:233], v[232:233], v[28:29]
    v_pk_mul_f32 v[244:245], v[244:245], v[28:29]
    v_cvt_pk_bf16_f32 v64, v140, v156
    v_cvt_pk_bf16_f32 v65, v172, v188
    ds_write_b64 v19, v[64:65] offset:4096
    s_waitcnt lgkmcnt(1)
    buffer_store_dwordx4 v[52:55], v22, s[16:19], s52 offen offset:768 nt
    v_cvt_pk_bf16_f32 v66, v204, v220
    v_cvt_pk_bf16_f32 v67, v232, v244
    ds_write_b64 v19, v[66:67] offset:4224
    ds_read_b64_tr_b16 v[64:65], v16 offset:4096
    ds_read_b64_tr_b16 v[66:67], v17 offset:4096
    v_cvt_pk_bf16_f32 v68, v141, v157
    v_cvt_pk_bf16_f32 v69, v173, v189
    ds_write_b64 v19, v[68:69] offset:4352
    v_cvt_pk_bf16_f32 v70, v205, v221
    v_cvt_pk_bf16_f32 v71, v233, v245
    ds_write_b64 v19, v[70:71] offset:4480
    ds_read_b64_tr_b16 v[68:69], v16 offset:4352
    ds_read_b64_tr_b16 v[70:71], v17 offset:4352
    v_pk_mul_f32 v[142:143], v[142:143], v[30:31]
    v_pk_mul_f32 v[158:159], v[158:159], v[30:31]
    v_pk_mul_f32 v[174:175], v[174:175], v[30:31]
    v_pk_mul_f32 v[190:191], v[190:191], v[30:31]
    v_pk_mul_f32 v[206:207], v[206:207], v[30:31]
    v_pk_mul_f32 v[222:223], v[222:223], v[30:31]
    v_pk_mul_f32 v[234:235], v[234:235], v[30:31]
    v_pk_mul_f32 v[246:247], v[246:247], v[30:31]
    v_cvt_pk_bf16_f32 v72, v142, v158
    v_cvt_pk_bf16_f32 v73, v174, v190
    ds_write_b64 v19, v[72:73] offset:4608
    s_waitcnt lgkmcnt(5)
    buffer_store_dwordx4 v[64:67], v22, s[16:19], s53 offen nt
    v_cvt_pk_bf16_f32 v74, v206, v222
    v_cvt_pk_bf16_f32 v75, v234, v246
    ds_write_b64 v19, v[74:75] offset:4736
    ds_read_b64_tr_b16 v[72:73], v16 offset:4608
    ds_read_b64_tr_b16 v[74:75], v17 offset:4608
    v_cvt_pk_bf16_f32 v76, v143, v159
    v_cvt_pk_bf16_f32 v77, v175, v191
    s_waitcnt lgkmcnt(4)
    buffer_store_dwordx4 v[68:71], v22, s[16:19], s53 offen offset:256 nt
    ds_write_b64 v19, v[76:77] offset:4864
    v_cvt_pk_bf16_f32 v78, v207, v223
    v_cvt_pk_bf16_f32 v79, v235, v247
    ds_write_b64 v19, v[78:79] offset:4992
    ds_read_b64_tr_b16 v[76:77], v16 offset:4864
    ds_read_b64_tr_b16 v[78:79], v17 offset:4864
    v_accvgpr_read_b32 v32, a232
    v_accvgpr_read_b32 v33, a233
    v_accvgpr_read_b32 v34, a234
    v_accvgpr_read_b32 v35, a235
    v_max3_f32 v18, v32, v33, v18
    v_max3_f32 v18, v34, v35, v18
    v_rcp_f32 v32, v32
    v_rcp_f32 v33, v33
    s_waitcnt lgkmcnt(4)
    buffer_store_dwordx4 v[72:75], v22, s[16:19], s53 offen offset:512 nt
    v_rcp_f32 v34, v34
    v_rcp_f32 v35, v35
    v_pk_mul_f32 v[144:145], v[144:145], v[32:33]
    v_pk_mul_f32 v[160:161], v[160:161], v[32:33]
    v_pk_mul_f32 v[176:177], v[176:177], v[32:33]
    v_pk_mul_f32 v[192:193], v[192:193], v[32:33]
    v_pk_mul_f32 v[208:209], v[208:209], v[32:33]
    v_pk_mul_f32 v[224:225], v[224:225], v[32:33]
    v_pk_mul_f32 v[236:237], v[236:237], v[32:33]
    v_pk_mul_f32 v[248:249], v[248:249], v[32:33]
    v_cvt_pk_bf16_f32 v88, v144, v160
    v_cvt_pk_bf16_f32 v89, v176, v192
    ds_write_b64 v19, v[88:89] offset:0
    s_waitcnt lgkmcnt(1)
    buffer_store_dwordx4 v[76:79], v22, s[16:19], s53 offen offset:768 nt
    v_cvt_pk_bf16_f32 v90, v208, v224
    v_cvt_pk_bf16_f32 v91, v236, v248
    ds_write_b64 v19, v[90:91] offset:128
    ds_read_b64_tr_b16 v[88:89], v16 offset:0
    ds_read_b64_tr_b16 v[90:91], v17 offset:0
    v_cvt_pk_bf16_f32 v92, v145, v161
    v_cvt_pk_bf16_f32 v93, v177, v193
    ds_write_b64 v19, v[92:93] offset:256
    v_cvt_pk_bf16_f32 v94, v209, v225
    v_cvt_pk_bf16_f32 v95, v237, v249
    ds_write_b64 v19, v[94:95] offset:384
    ds_read_b64_tr_b16 v[92:93], v16 offset:256
    ds_read_b64_tr_b16 v[94:95], v17 offset:256
    v_pk_mul_f32 v[146:147], v[146:147], v[34:35]
    v_pk_mul_f32 v[162:163], v[162:163], v[34:35]
    v_pk_mul_f32 v[178:179], v[178:179], v[34:35]
    v_pk_mul_f32 v[194:195], v[194:195], v[34:35]
    v_pk_mul_f32 v[210:211], v[210:211], v[34:35]
    v_pk_mul_f32 v[226:227], v[226:227], v[34:35]
    v_pk_mul_f32 v[238:239], v[238:239], v[34:35]
    v_pk_mul_f32 v[250:251], v[250:251], v[34:35]
    v_cvt_pk_bf16_f32 v96, v146, v162
    v_cvt_pk_bf16_f32 v97, v178, v194
    ds_write_b64 v19, v[96:97] offset:512
    s_waitcnt lgkmcnt(5)
    buffer_store_dwordx4 v[88:91], v22, s[16:19], s54 offen nt
    v_cvt_pk_bf16_f32 v98, v210, v226
    v_cvt_pk_bf16_f32 v99, v238, v250
    ds_write_b64 v19, v[98:99] offset:640
    ds_read_b64_tr_b16 v[96:97], v16 offset:512
    ds_read_b64_tr_b16 v[98:99], v17 offset:512
    v_cvt_pk_bf16_f32 v100, v147, v163
    v_cvt_pk_bf16_f32 v101, v179, v195
    s_waitcnt lgkmcnt(4)
    buffer_store_dwordx4 v[92:95], v22, s[16:19], s54 offen offset:256 nt
    ds_write_b64 v19, v[100:101] offset:768
    v_cvt_pk_bf16_f32 v102, v211, v227
    v_cvt_pk_bf16_f32 v103, v239, v251
    ds_write_b64 v19, v[102:103] offset:896
    ds_read_b64_tr_b16 v[100:101], v16 offset:768
    ds_read_b64_tr_b16 v[102:103], v17 offset:768
    v_accvgpr_read_b32 v36, a236
    v_accvgpr_read_b32 v37, a237
    v_accvgpr_read_b32 v38, a238
    v_accvgpr_read_b32 v39, a239
    v_max3_f32 v18, v36, v37, v18
    v_max3_f32 v18, v38, v39, v18
    v_rcp_f32 v36, v36
    v_rcp_f32 v37, v37
    s_waitcnt lgkmcnt(4)
    buffer_store_dwordx4 v[96:99], v22, s[16:19], s54 offen offset:512 nt
    v_rcp_f32 v38, v38
    v_rcp_f32 v39, v39
    v_pk_mul_f32 v[148:149], v[148:149], v[36:37]
    v_pk_mul_f32 v[164:165], v[164:165], v[36:37]
    v_pk_mul_f32 v[180:181], v[180:181], v[36:37]
    v_pk_mul_f32 v[196:197], v[196:197], v[36:37]
    v_pk_mul_f32 v[212:213], v[212:213], v[36:37]
    v_pk_mul_f32 v[228:229], v[228:229], v[36:37]
    v_pk_mul_f32 v[240:241], v[240:241], v[36:37]
    v_pk_mul_f32 v[252:253], v[252:253], v[36:37]
    v_cvt_pk_bf16_f32 v112, v148, v164
    v_cvt_pk_bf16_f32 v113, v180, v196
    ds_write_b64 v19, v[112:113] offset:4096
    s_waitcnt lgkmcnt(1)
    buffer_store_dwordx4 v[100:103], v22, s[16:19], s54 offen offset:768 nt
    v_cvt_pk_bf16_f32 v114, v212, v228
    v_cvt_pk_bf16_f32 v115, v240, v252
    ds_write_b64 v19, v[114:115] offset:4224
    ds_read_b64_tr_b16 v[112:113], v16 offset:4096
    ds_read_b64_tr_b16 v[114:115], v17 offset:4096
    v_cvt_pk_bf16_f32 v116, v149, v165
    v_cvt_pk_bf16_f32 v117, v181, v197
    ds_write_b64 v19, v[116:117] offset:4352
    v_cvt_pk_bf16_f32 v118, v213, v229
    v_cvt_pk_bf16_f32 v119, v241, v253
    ds_write_b64 v19, v[118:119] offset:4480
    ds_read_b64_tr_b16 v[116:117], v16 offset:4352
    ds_read_b64_tr_b16 v[118:119], v17 offset:4352
    v_pk_mul_f32 v[150:151], v[150:151], v[38:39]
    v_pk_mul_f32 v[166:167], v[166:167], v[38:39]
    v_pk_mul_f32 v[182:183], v[182:183], v[38:39]
    v_pk_mul_f32 v[198:199], v[198:199], v[38:39]
    v_pk_mul_f32 v[214:215], v[214:215], v[38:39]
    v_pk_mul_f32 v[230:231], v[230:231], v[38:39]
    v_pk_mul_f32 v[242:243], v[242:243], v[38:39]
    v_pk_mul_f32 v[254:255], v[254:255], v[38:39]
    v_cvt_pk_bf16_f32 v120, v150, v166
    v_cvt_pk_bf16_f32 v121, v182, v198
    ds_write_b64 v19, v[120:121] offset:4608
    s_waitcnt lgkmcnt(5)
    buffer_store_dwordx4 v[112:115], v22, s[16:19], s55 offen nt
    v_cvt_pk_bf16_f32 v122, v214, v230
    v_cvt_pk_bf16_f32 v123, v242, v254
    ds_write_b64 v19, v[122:123] offset:4736
    ds_read_b64_tr_b16 v[120:121], v16 offset:4608
    ds_read_b64_tr_b16 v[122:123], v17 offset:4608
    v_cvt_pk_bf16_f32 v124, v151, v167
    v_cvt_pk_bf16_f32 v125, v183, v199
    s_waitcnt lgkmcnt(4)
    buffer_store_dwordx4 v[116:119], v22, s[16:19], s55 offen offset:256 nt
    ds_write_b64 v19, v[124:125] offset:4864
    v_cvt_pk_bf16_f32 v126, v215, v231
    v_cvt_pk_bf16_f32 v127, v243, v255
    ds_write_b64 v19, v[126:127] offset:4992
    ds_read_b64_tr_b16 v[124:125], v16 offset:4864
    ds_read_b64_tr_b16 v[126:127], v17 offset:4864
    s_waitcnt lgkmcnt(4)
    buffer_store_dwordx4 v[120:123], v22, s[16:19], s55 offen offset:512 nt
    s_waitcnt lgkmcnt(0)
    buffer_store_dwordx4 v[124:127], v22, s[16:19], s55 offen offset:768 nt
    s_endpgm
.section .rodata,"a"
.p2align 6
.amdhsa_kernel standalone__mha_softmax__near_ridge_kernel
  .amdhsa_next_free_vgpr 512
  .amdhsa_next_free_sgpr 102
  .amdhsa_accum_offset 256
  .amdhsa_group_segment_fixed_size 0
  .amdhsa_kernarg_size 48
  .amdhsa_user_sgpr_count 2
  .amdhsa_user_sgpr_kernarg_segment_ptr 1
  .amdhsa_system_sgpr_workgroup_id_x 1
.end_amdhsa_kernel
```
